```python
import torch

def _softmax(x, axis=-1):
    return torch.softmax(x, dim=axis)
def _gelu(x):
    return torch.nn.functional.gelu(x, approximate="tanh")
def _silu(x):
    return torch.nn.functional.silu(x)
def _sigmoid(x):
    return torch.sigmoid(x)
def _layernorm(x, axis=-1, eps=1e-5):
    m = x.mean(dim=axis, keepdim=True)
    v = x.var(dim=axis, keepdim=True, unbiased=False)
    return (x - m) / torch.sqrt(v + eps)
def _scatter_add(tgt, idx, src, axis=0):
    return tgt.clone().index_add_(axis, idx, src)
def _segment_sum(src, seg, n):
    out = torch.zeros((n,) + src.shape[1:], dtype=src.dtype)
    return out.index_add_(0, seg, src)
def _pad(x, pw):
    flat = tuple(v for pair in reversed(pw) for v in pair)
    return torch.nn.functional.pad(x, flat)

kernel_name = 'parallel_sum__spectral_gfnet__dense_activation_gelu__prompt'

def setup_inputs():

    _w = (lambda a: (lambda t: t.to(torch.bfloat16) if t.is_floating_point() else t)(torch.as_tensor(a)))
    def _A_setup():
        B, S, D = 1, 2048, 640
        Df = D // 2 + 1
        return {
            "x": _w((lambda *s: torch.randn(*s, dtype=torch.bfloat16) * 0.05)(B, S, D)),
            "w_r": _w((lambda *s: torch.randn(*s, dtype=torch.bfloat16) * 0.8)(S, Df) * 0.02),
            "w_i": _w((lambda *s: torch.randn(*s, dtype=torch.bfloat16) * 0.8)(S, Df) * 0.02),
        }
    _A_in = _A_setup()

    def _B_setup():
        B, S, D, F = 1, 2048, 640, 1728
        return {
            "x": _w((lambda *s: torch.randn(*s, dtype=torch.bfloat16) * 0.05)(B, S, D)),
            "w1": _w((lambda *s: torch.randn(*s, dtype=torch.bfloat16) * 0.4)(D, F) * (D ** -0.5)),
            "b1": _w((lambda *s: torch.randn(*s, dtype=torch.bfloat16) * 12.8)(F) * 0.01),
            "w2": _w((lambda *s: torch.randn(*s, dtype=torch.bfloat16) * 0.2)(F, D) * (F ** -0.5)),
            "b2": _w((lambda *s: torch.randn(*s, dtype=torch.bfloat16) * 1.6)(D) * 0.01),
        }
    _B_in = _B_setup()

    return {
        "A_x": _A_in["x"],
        "A_w_r": _A_in["w_r"],
        "A_w_i": _A_in["w_i"],
        "B_x": _B_in["x"],
        "B_w1": _B_in["w1"],
        "B_b1": _B_in["b1"],
        "B_w2": _B_in["w2"],
        "B_b2": _B_in["b2"],
    }

def reference(A_x, A_w_r, A_w_i, B_x, B_w1, B_b1, B_w2, B_b2):
    def _A_ref(x, w_r, w_i):
        B, S, D = x.shape
        X = (lambda x, axes=(-2,-1): torch.fft.rfft2(x.float(), dim=axes))(x, axes=(-2, -1))
        W = w_r + 1j * w_i
        X = X * W
        y = (lambda x, s, axes=(-2,-1): torch.fft.irfft2(x, s=s, dim=axes).to(torch.bfloat16))(X, (S, D), axes=(-2, -1))
        return y

    def _B_ref(x, w1, b1, w2, b2):
        h = torch.einsum("bsd,df->bsf", x, w1) + b1
        h = _gelu(h)
        return torch.einsum("bsf,fd->bsd", h, w2) + b2

    x = A_x
    xn = _layernorm(x, axis=-1)
    return x + _A_ref(xn, A_w_r, A_w_i) + _B_ref(xn, B_w1, B_b1, B_w2, B_b2)
```

```asm
; @launch grid=(256,1,1) block=(512,1,1) lds=163840
.amdgcn_target "amdgcn-amd-amdhsa--gfx950"
.text
.globl parallel_sum__spectral_gfnet__dense_activation_gelu__prompt_kernel
.p2align 8
.type parallel_sum__spectral_gfnet__dense_activation_gelu__prompt_kernel,@function
parallel_sum__spectral_gfnet__dense_activation_gelu__prompt_kernel:
    s_cmp_ge_u32 s2, 256
    s_cbranch_scc1 A_END
    s_getpc_b64 s[70:71]
A_PC:
    v_readfirstlane_b32 s32, v0
    s_lshr_b32 s41, s2, 3
    v_lshlrev_b32 v10, 2, v0
    s_lshl_b32 s46, s41, 11
    v_add_u32 v10, s46, v10
    v_min_u32 v10, CODE_END-A_PC-4, v10
    v_mov_b32 v11, s71
    v_add_co_u32 v10, vcc, s70, v10
    s_lshr_b32 s32, s32, 6
    s_lshl_b32 s48, s2, 3
    v_addc_co_u32 v11, vcc, 0, v11, vcc
    s_add_u32 s48, s48, s32
    s_cmp_eq_u32 s48, 14
    s_cbranch_scc1 A_NT
    global_load_dword v255, v[10:11], off
A_NT:
    s_load_dwordx2 s[14:15], s[0:1], 80
    s_load_dwordx4 s[4:7], s[0:1], 0
    s_load_dwordx4 s[8:11], s[0:1], 32
    s_load_dwordx2 s[72:73], s[0:1], 72
    s_load_dwordx2 s[12:13], s[0:1], 48
    s_load_dwordx2 s[74:75], s[0:1], 16
    v_and_b32 v0, 63, v0
    s_cbranch_scc0 A_NI
    v_lshlrev_b32 v4, 8, v0
    v_mov_b32 v5, 0
    s_movk_i32 s46, 16384
    s_mov_b32 s66, 1
    s_waitcnt lgkmcnt(0)
    s_add_u32 s56, s14, 20971520
    s_addc_u32 s57, s15, 0
    s_mov_b32 s58, 28672
    s_mov_b32 s59, 0x20000
    buffer_store_dword v5, v4, s[56:59], 0 offen sc1
    buffer_store_dword v5, v4, s[56:59], s46 offen sc1
    s_waitcnt vmcnt(0)
    s_atomic_or s66, s[72:73], 0
    global_load_dword v255, v[10:11], off
A_NI:
    s_and_b32 s40, s2, 7
    s_lshr_b32 s42, s40, 1
    s_and_b32 s43, s40, 1
    s_lshr_b32 s44, s41, 3
    s_and_b32 s45, s41, 7
    s_lshl_b32 s33, s42, 2
    s_add_u32 s33, s33, s44
    s_mul_i32 s34, s43, 5
    s_add_u32 s34, s34, s45
    s_add_u32 s46, s44, s45
    s_and_b32 s46, s46, 3
    s_mul_i32 s46, s46, 5
    s_add_u32 s46, s46, 1
    s_lshr_b32 s46, s46, 1
    s_add_u32 s35, s46, s42
    s_cmp_ge_u32 s35, 10
    s_cselect_b32 s46, 10, 0
    s_sub_u32 s35, s35, s46
    s_mul_i32 s37, s34, 160
    s_min_u32 s37, s37, 1568
    s_lshl_b32 s46, s43, 1
    s_add_u32 s46, s46, s45
    s_sub_u32 s46, s46, 5
    s_and_b32 s48, s46, 0
    s_add_u32 s47, s43, 5
    s_cmp_ge_u32 s45, s47
    s_cselect_b32 s34, s46, s34
    s_cselect_b32 s35, s48, s35
    v_and_b32 v1, 15, v0
    v_lshrrev_b32 v2, 4, v0
    v_lshlrev_b32 v3, 4, v0
    s_cmp_lg_u32 s32, 4
    s_cbranch_scc1 A_NOTLD
    s_setprio 3
    v_lshrrev_b32 v8, 3, v0
    v_mul_u32_u24 v8, 81920, v8
    v_and_b32 v4, 7, v0
    v_xor_b32 v4, v4, v2
    v_lshl_add_u32 v4, v4, 4, v8
    v_xor_b32 v5, 64, v4
    v_add_u32 v5, 654336, v5
    v_add_u32 v6, 1308672, v4
    v_add_u32 v7, 1308672, v5
    s_mul_i32 s52, s33, 5120
    s_sub_u32 s52, s52, 1280
    s_mov_b32 s50, 0
    s_mov_b32 s54, 0
    s_mov_b32 s49, s35
    s_mov_b32 s18, 2621440
    s_mov_b32 s19, 0x20000
    s_cmp_ge_u32 s45, s47
    s_waitcnt lgkmcnt(0)
    s_mov_b64 s[16:17], s[4:5]
    s_cbranch_scc1 A_LDD
A_LDMP:
    s_waitcnt vmcnt(15)
A_LDM:
    s_lshl_b32 s51, s49, 7
    s_add_u32 s51, s51, s52
    s_add_u32 m0, s50, 0
    s_add_u32 s51, s51, 1280
    buffer_load_dwordx4 v4, s[16:19], s51 offen offset:0 lds
    buffer_load_dwordx4 v5, s[16:19], s51 offen offset:1024 lds
    buffer_load_dwordx4 v6, s[16:19], s51 offen offset:2048 lds
    buffer_load_dwordx4 v7, s[16:19], s51 offen offset:3072 lds
    s_add_u32 m0, s50, 4096
    s_add_u32 s51, s51, 1280
    buffer_load_dwordx4 v4, s[16:19], s51 offen offset:0 lds
    buffer_load_dwordx4 v5, s[16:19], s51 offen offset:1024 lds
    buffer_load_dwordx4 v6, s[16:19], s51 offen offset:2048 lds
    buffer_load_dwordx4 v7, s[16:19], s51 offen offset:3072 lds
    s_add_u32 m0, s50, 8192
    s_add_u32 s51, s51, 1280
    buffer_load_dwordx4 v4, s[16:19], s51 offen offset:0 lds
    buffer_load_dwordx4 v5, s[16:19], s51 offen offset:1024 lds
    buffer_load_dwordx4 v6, s[16:19], s51 offen offset:2048 lds
    buffer_load_dwordx4 v7, s[16:19], s51 offen offset:3072 lds
    s_add_u32 m0, s50, 12288
    s_add_u32 s51, s51, 1280
    buffer_load_dwordx4 v4, s[16:19], s51 offen offset:0 lds
    buffer_load_dwordx4 v5, s[16:19], s51 offen offset:1024 lds
    buffer_load_dwordx4 v6, s[16:19], s51 offen offset:2048 lds
    buffer_load_dwordx4 v7, s[16:19], s51 offen offset:3072 lds
    s_add_u32 s49, s49, 1
    s_cmp_eq_u32 s49, 10
    s_cselect_b32 s49, 0, s49
    s_add_u32 s50, s50, 36864
    s_cmp_eq_u32 s50, 110592
    s_cselect_b32 s50, 0, s50
    s_add_u32 s54, s54, 1
    s_cmp_eq_u32 s54, 1
    s_cbranch_scc1 A_LDMP
    s_cmp_lt_u32 s54, 10
    s_waitcnt vmcnt(16)
    s_barrier
    s_cbranch_scc1 A_LDM
    s_waitcnt vmcnt(0)
    s_barrier
    s_barrier
    s_branch B_LH
A_LDD:
    s_lshl_b32 s51, s49, 7
    s_add_u32 s51, s51, s52
    s_add_u32 m0, s50, 0
    s_add_u32 s51, s51, 1280
    buffer_load_dwordx4 v4, s[16:19], s51 offen offset:0 lds
    buffer_load_dwordx4 v5, s[16:19], s51 offen offset:1024 lds
    buffer_load_dwordx4 v6, s[16:19], s51 offen offset:2048 lds
    buffer_load_dwordx4 v7, s[16:19], s51 offen offset:3072 lds
    s_add_u32 m0, s50, 4096
    s_add_u32 s51, s51, 1280
    buffer_load_dwordx4 v4, s[16:19], s51 offen offset:0 lds
    buffer_load_dwordx4 v5, s[16:19], s51 offen offset:1024 lds
    buffer_load_dwordx4 v6, s[16:19], s51 offen offset:2048 lds
    buffer_load_dwordx4 v7, s[16:19], s51 offen offset:3072 lds
    s_add_u32 m0, s50, 8192
    s_add_u32 s51, s51, 1280
    buffer_load_dwordx4 v4, s[16:19], s51 offen offset:0 lds
    buffer_load_dwordx4 v5, s[16:19], s51 offen offset:1024 lds
    buffer_load_dwordx4 v6, s[16:19], s51 offen offset:2048 lds
    buffer_load_dwordx4 v7, s[16:19], s51 offen offset:3072 lds
    s_add_u32 m0, s50, 12288
    s_add_u32 s51, s51, 1280
    buffer_load_dwordx4 v4, s[16:19], s51 offen offset:0 lds
    buffer_load_dwordx4 v5, s[16:19], s51 offen offset:1024 lds
    buffer_load_dwordx4 v6, s[16:19], s51 offen offset:2048 lds
    buffer_load_dwordx4 v7, s[16:19], s51 offen offset:3072 lds
    s_cmp_ge_u32 s49, 5
    s_cselect_b32 s58, 1280, 0
    s_sub_u32 s51, s51, s58
    s_sub_u32 s51, s51, 4480
    s_add_u32 m0, s50, 16384
    s_add_u32 s51, s51, 1280
    buffer_load_dwordx4 v4, s[16:19], s51 offen offset:0 lds
    buffer_load_dwordx4 v5, s[16:19], s51 offen offset:1024 lds
    buffer_load_dwordx4 v6, s[16:19], s51 offen offset:2048 lds
    buffer_load_dwordx4 v7, s[16:19], s51 offen offset:3072 lds
    s_add_u32 m0, s50, 20480
    s_add_u32 s51, s51, 1280
    buffer_load_dwordx4 v4, s[16:19], s51 offen offset:0 lds
    buffer_load_dwordx4 v5, s[16:19], s51 offen offset:1024 lds
    buffer_load_dwordx4 v6, s[16:19], s51 offen offset:2048 lds
    buffer_load_dwordx4 v7, s[16:19], s51 offen offset:3072 lds
    s_add_u32 m0, s50, 24576
    s_add_u32 s51, s51, 1280
    buffer_load_dwordx4 v4, s[16:19], s51 offen offset:0 lds
    buffer_load_dwordx4 v5, s[16:19], s51 offen offset:1024 lds
    buffer_load_dwordx4 v6, s[16:19], s51 offen offset:2048 lds
    buffer_load_dwordx4 v7, s[16:19], s51 offen offset:3072 lds
    s_add_u32 m0, s50, 28672
    s_add_u32 s51, s51, 1280
    buffer_load_dwordx4 v4, s[16:19], s51 offen offset:0 lds
    buffer_load_dwordx4 v5, s[16:19], s51 offen offset:1024 lds
    buffer_load_dwordx4 v6, s[16:19], s51 offen offset:2048 lds
    buffer_load_dwordx4 v7, s[16:19], s51 offen offset:3072 lds
    s_cmp_lg_u32 s54, 0
    s_cbranch_scc1 A_LDD0
    s_and_b32 s54, s32, 3
    s_lshl_b32 s46, s33, 2
    s_add_u32 s46, s46, s54
    v_lshlrev_b32 v14, 8, v2
    v_add_u32 v14, s46, v14
    v_cvt_f32_u32 v14, v14
    v_add_u32 v15, 0, v1
    v_cvt_f32_u32 v15, v15
    v_mul_f32 v15, 0x3a000000, v15
    v_mul_f32 v84, v15, v14
    v_mul_f32 v15, 0x42800000, v15
    v_add_f32 v85, v15, v84
    v_add_f32 v86, v15, v85
    v_add_f32 v87, v15, v86
    v_sin_f32 v88, v84
    v_cos_f32 v84, v84
    v_sin_f32 v89, v85
    v_cos_f32 v85, v85
    v_sin_f32 v90, v86
    v_cos_f32 v86, v86
    v_sin_f32 v91, v87
    v_cos_f32 v87, v87
    v_add_u32 v15, 16, v1
    v_cvt_f32_u32 v15, v15
    v_mul_f32 v15, 0x3a000000, v15
    v_mul_f32 v92, v15, v14
    v_mul_f32 v15, 0x42800000, v15
    v_add_f32 v93, v15, v92
    v_add_f32 v94, v15, v93
    v_add_f32 v95, v15, v94
    v_sin_f32 v96, v92
    v_cos_f32 v92, v92
    v_sin_f32 v97, v93
    v_cos_f32 v93, v93
    v_sin_f32 v98, v94
    v_cos_f32 v94, v94
    v_sin_f32 v99, v95
    v_cos_f32 v95, v95
    s_mov_b32 s54, 0
A_LDD0:
    s_cmp_lg_u32 s54, 4
    s_cbranch_scc1 A_LDD1
    s_waitcnt vmcnt(0)
A_LDD1:
    s_add_u32 s49, s49, 1
    s_cmp_eq_u32 s49, 10
    s_cselect_b32 s49, 0, s49
    s_add_u32 s50, s50, 32768
    s_cmp_eq_u32 s50, 98304
    s_cselect_b32 s50, 0, s50
    s_add_u32 s54, s54, 1
    s_cmp_eq_u32 s54, 1
    s_cbranch_scc1 A_LDD
    s_cmp_lt_u32 s54, 5
    s_waitcnt vmcnt(32)
    s_barrier
    s_cbranch_scc1 A_LDD
    s_setprio 0
    s_add_u32 s56, s14, 20971520
    s_addc_u32 s57, s15, 0
    s_mov_b32 s58, 28672
    s_mov_b32 s59, 0x20000
    s_mov_b64 s[20:21], s[12:13]
    s_mov_b32 s22, 2211840
    s_mov_b32 s23, 0x20000
    v_mov_b32 v9, v3
    v_mov_b32 v10, v3
    v_mov_b32 v11, v3
    v_mov_b32 v12, v3
    v_mov_b32 v13, v3
    s_branch A_D3w
A_NOTLD:
    s_cmp_lt_u32 s32, 4
    s_cbranch_scc1 A_COMPUTE
    s_cmp_ge_u32 s45, s47
    s_cbranch_scc1 A_DH0
    s_cmp_lg_u32 s32, 5
    s_cbranch_scc1 A_DH0
    s_setprio 3
    s_mov_b32 s52, 214748365
    v_add_u32 v14, 0, v0
    v_mul_hi_u32 v15, v14, s52
    v_mul_u32_u24 v8, 20, v15
    v_sub_u32 v8, v14, v8
    v_lshrrev_b32 v14, 2, v15
    v_and_b32 v14, 2, v14
    v_xor_b32 v8, v8, v14
    v_mul_u32_u24 v15, 3456, v15
    v_lshl_add_u32 v9, v8, 4, v15
    v_add_u32 v14, 64, v0
    v_mul_hi_u32 v15, v14, s52
    v_mul_u32_u24 v8, 20, v15
    v_sub_u32 v8, v14, v8
    v_lshrrev_b32 v14, 2, v15
    v_and_b32 v14, 2, v14
    v_xor_b32 v8, v8, v14
    v_mul_u32_u24 v15, 3456, v15
    v_lshl_add_u32 v10, v8, 4, v15
    v_subrev_u32 v10, 1024, v10
    v_add_u32 v14, 128, v0
    v_mul_hi_u32 v15, v14, s52
    v_mul_u32_u24 v8, 20, v15
    v_sub_u32 v8, v14, v8
    v_lshrrev_b32 v14, 2, v15
    v_and_b32 v14, 2, v14
    v_xor_b32 v8, v8, v14
    v_mul_u32_u24 v15, 3456, v15
    v_lshl_add_u32 v11, v8, 4, v15
    v_subrev_u32 v11, 2048, v11
    v_add_u32 v14, 192, v0
    v_mul_hi_u32 v15, v14, s52
    v_mul_u32_u24 v8, 20, v15
    v_sub_u32 v8, v14, v8
    v_lshrrev_b32 v14, 2, v15
    v_and_b32 v14, 2, v14
    v_xor_b32 v8, v8, v14
    v_mul_u32_u24 v15, 3456, v15
    v_lshl_add_u32 v12, v8, 4, v15
    v_subrev_u32 v12, 3072, v12
    v_add_u32 v14, 256, v0
    v_mul_hi_u32 v15, v14, s52
    v_mul_u32_u24 v8, 20, v15
    v_sub_u32 v8, v14, v8
    v_lshrrev_b32 v14, 2, v15
    v_and_b32 v14, 2, v14
    v_xor_b32 v8, v8, v14
    v_mul_u32_u24 v15, 3456, v15
    v_lshl_add_u32 v13, v8, 4, v15
    s_mov_b32 s49, s35
    s_lshl_b32 s52, s37, 1
    s_sub_u32 s52, s52, 55296
    s_mov_b32 s50, 0
    s_mov_b32 s54, 0
    s_waitcnt lgkmcnt(0)
    s_mov_b64 s[20:21], s[8:9]
    s_mov_b32 s22, 2211840
    s_mov_b32 s23, 0x20000
A_LDW:
    s_mul_i32 s53, s49, 221184
    s_add_u32 s53, s53, s52
    s_add_u32 m0, s50, 16384
    s_add_u32 s53, s53, 55296
    buffer_load_dwordx4 v9, s[20:23], s53 offen offset:0 lds
    buffer_load_dwordx4 v10, s[20:23], s53 offen offset:1024 lds
    buffer_load_dwordx4 v11, s[20:23], s53 offen offset:2048 lds
    buffer_load_dwordx4 v12, s[20:23], s53 offen offset:3072 lds
    s_add_u32 m0, s50, 20480
    s_nop 0
    buffer_load_dwordx4 v13, s[20:23], s53 offen lds
    s_add_u32 m0, s50, 21504
    s_add_u32 s53, s53, 55296
    buffer_load_dwordx4 v9, s[20:23], s53 offen offset:0 lds
    buffer_load_dwordx4 v10, s[20:23], s53 offen offset:1024 lds
    buffer_load_dwordx4 v11, s[20:23], s53 offen offset:2048 lds
    buffer_load_dwordx4 v12, s[20:23], s53 offen offset:3072 lds
    s_add_u32 m0, s50, 25600
    s_nop 0
    buffer_load_dwordx4 v13, s[20:23], s53 offen lds
    s_add_u32 m0, s50, 26624
    s_add_u32 s53, s53, 55296
    buffer_load_dwordx4 v9, s[20:23], s53 offen offset:0 lds
    buffer_load_dwordx4 v10, s[20:23], s53 offen offset:1024 lds
    buffer_load_dwordx4 v11, s[20:23], s53 offen offset:2048 lds
    buffer_load_dwordx4 v12, s[20:23], s53 offen offset:3072 lds
    s_add_u32 m0, s50, 30720
    s_nop 0
    buffer_load_dwordx4 v13, s[20:23], s53 offen lds
    s_add_u32 m0, s50, 31744
    s_add_u32 s53, s53, 55296
    buffer_load_dwordx4 v9, s[20:23], s53 offen offset:0 lds
    buffer_load_dwordx4 v10, s[20:23], s53 offen offset:1024 lds
    buffer_load_dwordx4 v11, s[20:23], s53 offen offset:2048 lds
    buffer_load_dwordx4 v12, s[20:23], s53 offen offset:3072 lds
    s_add_u32 m0, s50, 35840
    s_nop 0
    buffer_load_dwordx4 v13, s[20:23], s53 offen lds
    s_add_u32 s49, s49, 1
    s_cmp_eq_u32 s49, 10
    s_cselect_b32 s49, 0, s49
    s_add_u32 s50, s50, 36864
    s_cmp_eq_u32 s50, 110592
    s_cselect_b32 s50, 0, s50
    s_add_u32 s54, s54, 1
    s_cmp_eq_u32 s54, 1
    s_cbranch_scc1 A_LDW
    s_cmp_lt_u32 s54, 10
    s_waitcnt vmcnt(20)
    s_barrier
    s_cbranch_scc1 A_LDW
    s_waitcnt vmcnt(0)
    s_barrier
    s_barrier
    s_branch B_LW
A_MH:
    s_mul_i32 s46, s43, 20
    s_mul_i32 s39, s44, s47
    s_add_u32 s46, s46, s39
    s_add_u32 s55, s46, s45
    s_mul_i32 s71, s55, 26
    s_lshr_b32 s71, s71, 8
    s_mul_i32 s46, s71, 10
    s_sub_u32 s39, s55, s46
    s_lshl_b32 s39, s39, 1
    s_and_b32 s46, s32, 1
    s_add_u32 s39, s39, s46
    s_lshl_b32 s70, s46, 13
    s_add_u32 s70, s70, 129024
    s_lshl_b32 s46, s42, 3
    s_add_u32 s71, s71, s46
    s_add_u32 s71, s71, 4
    v_mov_b32 v4, 159744
    v_mov_b32 v5, 0
    ds_write_b32 v4, v5
    s_mov_b64 s[28:29], s[10:11]
    s_mov_b32 s30, 3456
    s_mov_b32 s31, 0x20000
    v_lshlrev_b32 v4, 3, v0
    s_lshl_b32 s46, s37, 1
    buffer_load_dwordx2 v[160:161], v4, s[28:31], s46 offen
    v_lshrrev_b32 v4, 2, v1
    v_lshl_add_u32 v4, v2, 3, v4
    v_mul_u32_u24 v4, 320, v4
    v_and_b32 v6, 3, v1
    v_lshl_add_u32 v4, v6, 3, v4
    v_add_u32 v4, 16384, v4
    v_and_b32 v5, 1, v2
    v_lshlrev_b32 v5, 5, v5
    s_add_u32 s24, s14, 23068672
    s_addc_u32 s25, s15, 0
    s_mov_b32 s26, 70400
    s_mov_b32 s27, 0x20000
    s_and_b32 s48, s32, 1
    s_mul_i32 s46, s48, 160
    v_add_u32 v4, s46, v4
    s_lshl_b32 s46, s48, 1
    s_sub_u32 s46, 1, s46
    v_mul_i32_i24 v5, s46, v5
    v_add_u32 v6, v4, v5
    v_sub_u32 v7, v4, v5
    v_lshlrev_b32 v8, 2, v1
    v_lshl_add_u32 v8, v2, 28, v8
    s_mul_i32 s49, s34, 6400
    s_mul_i32 s46, s35, 640
    s_add_u32 s50, s49, s46
    s_mul_i32 s46, s48, 320
    s_add_u32 s50, s50, s46
    s_add_u32 s51, s34, 64
    s_lshl_b32 s51, s51, 8
    s_add_u32 s53, s33, 48
    s_lshl_b32 s53, s53, 8
    s_cmp_eq_u32 s48, 0
    s_mov_b32 s52, s53
    s_cselect_b32 s53, s53, s51
    s_cselect_b32 s54, 16, 32
    s_add_u32 s20, s14, 22020096
    s_addc_u32 s21, s15, 0
    s_mov_b32 s22, 16384
    s_mov_b32 s23, 0x20000
    v_mov_b32 v12, 0x3f803f80
    v_mov_b32 v13, 0x3f803f80
    v_mov_b32 v14, 0x3f803f80
    v_mov_b32 v15, 0x3f803f80
    s_waitcnt lgkmcnt(0)
    s_cmp_ge_u32 s36, 16
    s_cbranch_scc1 L_1
    v_mov_b32 v164, 0
    v_mov_b32 v165, 0
    v_mov_b32 v166, 0
    v_mov_b32 v167, 0
    s_waitcnt vmcnt(1)
    s_load_dword s69, s[72:73], 0
    v_dot2c_f32_bf16 v164, v212, v12
    v_dot2c_f32_bf16 v165, v212, v212
    v_dot2c_f32_bf16 v166, v213, v12
    v_dot2c_f32_bf16 v167, v213, v213
    v_dot2c_f32_bf16 v164, v214, v12
    v_dot2c_f32_bf16 v165, v214, v214
    v_dot2c_f32_bf16 v166, v215, v12
    v_dot2c_f32_bf16 v167, v215, v215
    v_dot2c_f32_bf16 v164, v216, v12
    v_dot2c_f32_bf16 v165, v216, v216
    v_dot2c_f32_bf16 v166, v217, v12
    v_dot2c_f32_bf16 v167, v217, v217
    v_dot2c_f32_bf16 v164, v218, v12
    v_dot2c_f32_bf16 v165, v218, v218
    v_dot2c_f32_bf16 v166, v219, v12
    v_dot2c_f32_bf16 v167, v219, v219
    v_dot2c_f32_bf16 v164, v220, v12
    v_dot2c_f32_bf16 v165, v220, v220
    v_dot2c_f32_bf16 v166, v221, v12
    v_dot2c_f32_bf16 v167, v221, v221
    v_dot2c_f32_bf16 v164, v222, v12
    v_dot2c_f32_bf16 v165, v222, v222
    v_dot2c_f32_bf16 v166, v223, v12
    v_dot2c_f32_bf16 v167, v223, v223
    v_dot2c_f32_bf16 v164, v224, v12
    v_dot2c_f32_bf16 v165, v224, v224
    v_dot2c_f32_bf16 v166, v225, v12
    v_dot2c_f32_bf16 v167, v225, v225
    v_dot2c_f32_bf16 v164, v226, v12
    v_dot2c_f32_bf16 v165, v226, v226
    v_dot2c_f32_bf16 v166, v227, v12
    v_dot2c_f32_bf16 v167, v227, v227
    v_dot2c_f32_bf16 v164, v228, v12
    v_dot2c_f32_bf16 v165, v228, v228
    v_dot2c_f32_bf16 v166, v229, v12
    v_dot2c_f32_bf16 v167, v229, v229
    v_dot2c_f32_bf16 v164, v230, v12
    v_dot2c_f32_bf16 v165, v230, v230
    v_dot2c_f32_bf16 v166, v231, v12
    v_dot2c_f32_bf16 v167, v231, v231
    v_dot2c_f32_bf16 v164, v232, v12
    v_dot2c_f32_bf16 v165, v232, v232
    v_dot2c_f32_bf16 v166, v233, v12
    v_dot2c_f32_bf16 v167, v233, v233
    v_dot2c_f32_bf16 v164, v234, v12
    v_dot2c_f32_bf16 v165, v234, v234
    v_dot2c_f32_bf16 v166, v235, v12
    v_dot2c_f32_bf16 v167, v235, v235
    v_dot2c_f32_bf16 v164, v236, v12
    v_dot2c_f32_bf16 v165, v236, v236
    v_dot2c_f32_bf16 v166, v237, v12
    v_dot2c_f32_bf16 v167, v237, v237
    v_dot2c_f32_bf16 v164, v238, v12
    v_dot2c_f32_bf16 v165, v238, v238
    v_dot2c_f32_bf16 v166, v239, v12
    v_dot2c_f32_bf16 v167, v239, v239
    v_dot2c_f32_bf16 v164, v240, v12
    v_dot2c_f32_bf16 v165, v240, v240
    v_dot2c_f32_bf16 v166, v241, v12
    v_dot2c_f32_bf16 v167, v241, v241
    v_dot2c_f32_bf16 v164, v242, v12
    v_dot2c_f32_bf16 v165, v242, v242
    v_dot2c_f32_bf16 v166, v243, v12
    v_dot2c_f32_bf16 v167, v243, v243
    v_dot2c_f32_bf16 v164, v244, v12
    v_dot2c_f32_bf16 v165, v244, v244
    v_dot2c_f32_bf16 v166, v245, v12
    v_dot2c_f32_bf16 v167, v245, v245
    v_dot2c_f32_bf16 v164, v246, v12
    v_dot2c_f32_bf16 v165, v246, v246
    v_dot2c_f32_bf16 v166, v247, v12
    v_dot2c_f32_bf16 v167, v247, v247
    v_dot2c_f32_bf16 v164, v248, v12
    v_dot2c_f32_bf16 v165, v248, v248
    v_dot2c_f32_bf16 v166, v249, v12
    v_dot2c_f32_bf16 v167, v249, v249
    v_dot2c_f32_bf16 v164, v250, v12
    v_dot2c_f32_bf16 v165, v250, v250
    v_dot2c_f32_bf16 v166, v251, v12
    v_dot2c_f32_bf16 v167, v251, v251
    s_nop 1
    v_add_f32 v164, v164, v166
    v_add_f32 v165, v165, v167
    s_nop 0
    v_add_f32_dpp v164, v164, v164 quad_perm:[1,0,3,2] row_mask:0xf bank_mask:0xf
    v_add_f32_dpp v165, v165, v165 quad_perm:[1,0,3,2] row_mask:0xf bank_mask:0xf
    s_nop 0
    v_add_f32_dpp v164, v164, v164 quad_perm:[2,3,0,1] row_mask:0xf bank_mask:0xf
    v_add_f32_dpp v165, v165, v165 quad_perm:[2,3,0,1] row_mask:0xf bank_mask:0xf
    s_nop 0
    v_add_f32_dpp v164, v164, v164 row_half_mirror row_mask:0xf bank_mask:0xf
    v_add_f32_dpp v165, v165, v165 row_half_mirror row_mask:0xf bank_mask:0xf
    v_mul_f32 v164, 0x3acccccd, v164
    v_mul_f32 v165, 0x3acccccd, v165
    v_fma_f32 v165, -v164, v164, v165
    v_max_f32 v165, 0, v165
    v_cvt_pk_bf16_f32 v165, v165, v165
    v_lshlrev_b32 v165, 16, v165
    v_add_f32 v165, 0x3727c5ac, v165
    v_cvt_pk_bf16_f32 v165, v165, v165
    v_lshlrev_b32 v165, 16, v165
    v_sqrt_f32 v165, v165
    s_nop 0
    v_cvt_pk_bf16_f32 v165, v165, v165
    v_lshlrev_b32 v165, 16, v165
    v_and_b32 v9, 7, v0
    v_lshl_add_u32 v9, v9, 28, v0
    s_lshl_b32 s46, s33, 4
    s_add_u32 s46, s46, s36
    s_lshl_b32 s46, s46, 6
    buffer_store_dwordx2 v[164:165], v9, s[20:23], s46 offen sc1
L_1:
    s_barrier
    s_cmp_lt_u32 s36, 16
    s_cbranch_scc1 A_MH1
    s_load_dword s69, s[72:73], 0
A_MH1:
    ds_read_b64_tr_b16 v[80:81], v6 offset:0
    ds_read_b64_tr_b16 v[82:83], v6 offset:1280
    ds_read_b64_tr_b16 v[84:85], v7 offset:32
    ds_read_b64_tr_b16 v[86:87], v7 offset:1312
    ds_read_b64_tr_b16 v[88:89], v6 offset:64
    ds_read_b64_tr_b16 v[90:91], v6 offset:1344
    ds_read_b64_tr_b16 v[92:93], v7 offset:96
    ds_read_b64_tr_b16 v[94:95], v7 offset:1376
    ds_read_b64_tr_b16 v[96:97], v6 offset:128
    ds_read_b64_tr_b16 v[98:99], v6 offset:1408
    ds_read_b64_tr_b16 v[100:101], v6 offset:10240
    ds_read_b64_tr_b16 v[102:103], v6 offset:11520
    ds_read_b64_tr_b16 v[104:105], v7 offset:10272
    ds_read_b64_tr_b16 v[106:107], v7 offset:11552
    ds_read_b64_tr_b16 v[108:109], v6 offset:10304
    ds_read_b64_tr_b16 v[110:111], v6 offset:11584
    ds_read_b64_tr_b16 v[112:113], v7 offset:10336
    ds_read_b64_tr_b16 v[114:115], v7 offset:11616
    ds_read_b64_tr_b16 v[116:117], v6 offset:10368
    ds_read_b64_tr_b16 v[118:119], v6 offset:11648
    s_waitcnt lgkmcnt(15)
    v_mfma_f32_16x16x32_bf16 v[124:127], v[12:15], v[80:83], 0
    v_mfma_f32_16x16x32_bf16 v[128:131], v[12:15], v[84:87], 0
    s_waitcnt lgkmcnt(14)
    v_mfma_f32_16x16x32_bf16 v[132:135], v[12:15], v[88:91], 0
    s_waitcnt lgkmcnt(12)
    v_mfma_f32_16x16x32_bf16 v[136:139], v[12:15], v[92:95], 0
    s_waitcnt lgkmcnt(10)
    v_mfma_f32_16x16x32_bf16 v[140:143], v[12:15], v[96:99], 0
    s_waitcnt lgkmcnt(8)
    v_mfma_f32_16x16x32_bf16 v[124:127], v[12:15], v[100:103], v[124:127]
    s_waitcnt lgkmcnt(6)
    v_mfma_f32_16x16x32_bf16 v[128:131], v[12:15], v[104:107], v[128:131]
    s_waitcnt lgkmcnt(4)
    v_mfma_f32_16x16x32_bf16 v[132:135], v[12:15], v[108:111], v[132:135]
    s_waitcnt lgkmcnt(2)
    v_mfma_f32_16x16x32_bf16 v[136:139], v[12:15], v[112:115], v[136:139]
    s_waitcnt lgkmcnt(0)
    v_mfma_f32_16x16x32_bf16 v[140:143], v[12:15], v[116:119], v[140:143]
    s_waitcnt lgkmcnt(0)
    s_cmp_lg_u32 s69, 0
    s_cbranch_scc1 L_3
    s_mov_b32 s61, 50000
    v_mov_b32 v252, 0
L_2:
    s_sleep 8
    global_load_dword v253, v252, s[72:73] sc1
    s_waitcnt vmcnt(0)
    v_readfirstlane_b32 s69, v253
    s_nop 1
    s_cmp_lg_u32 s69, 0
    s_cbranch_scc1 L_3
    s_sub_u32 s61, s61, 1
    s_cmp_lg_u32 s61, 0
    s_cbranch_scc1 L_2
L_3:
    s_cmp_ge_u32 s36, 16
    s_cbranch_scc1 A_MH2
    s_mov_b32 s66, 1
    s_waitcnt vmcnt(0)
    s_atomic_add s66, s[56:57], s52
A_MH2:
    buffer_store_dword v124, v8, s[24:27], s50 offen offset:0 sc1
    buffer_store_dword v128, v8, s[24:27], s50 offen offset:64 sc1
    buffer_store_dword v132, v8, s[24:27], s50 offen offset:128 sc1
    buffer_store_dword v136, v8, s[24:27], s50 offen offset:192 sc1
    buffer_store_dword v140, v8, s[24:27], s50 offen offset:256 sc1
    s_barrier
    s_barrier
    s_barrier
    s_mov_b32 s66, 1
    s_waitcnt vmcnt(0)
    s_atomic_add s66, s[56:57], s51
    s_barrier
    s_barrier
    s_barrier
    s_barrier
    s_waitcnt lgkmcnt(0)
    s_mov_b32 s60, 0
    s_atomic_add s60, s[56:57], s53 glc
    s_barrier
    s_mov_b32 s61, 100000
    s_branch L_6
L_4:
    s_mov_b32 s60, 0
    s_atomic_add s60, s[56:57], s53 glc
L_6:
    s_waitcnt lgkmcnt(0)
    s_bfe_u32 s60, s60, 524288
    s_cmp_eq_u32 s60, s54
    s_cbranch_scc1 L_5
    s_sub_u32 s61, s61, 1
    s_cmp_eq_u32 s61, 0
    s_cbranch_scc1 L_5
    s_sleep 2
    s_branch L_4
L_5:
    s_cmp_eq_u32 s48, 0
    s_cbranch_scc0 A_MH7
    s_add_u32 s28, s14, 22020096
    s_addc_u32 s29, s15, 0
    s_mov_b32 s30, 16384
    s_mov_b32 s31, 0x20000
    s_lshl_b32 s46, s33, 10
    buffer_load_dwordx4 v[224:227], v3, s[28:31], s46 offen sc1
    s_sleep 2
    s_branch A_MH7b
A_MH7:
    s_mov_b32 exec_hi, 0xff
    s_add_u32 s50, s49, 3200
    buffer_load_dwordx4 v[80:83], v3, s[24:27], s49 offen offset:0 sc1
    buffer_load_dwordx4 v[84:87], v3, s[24:27], s49 offen offset:640 sc1
    buffer_load_dwordx4 v[88:91], v3, s[24:27], s49 offen offset:1280 sc1
    buffer_load_dwordx4 v[92:95], v3, s[24:27], s49 offen offset:1920 sc1
    buffer_load_dwordx4 v[96:99], v3, s[24:27], s49 offen offset:2560 sc1
    buffer_load_dwordx4 v[100:103], v3, s[24:27], s50 offen offset:0 sc1
    buffer_load_dwordx4 v[104:107], v3, s[24:27], s50 offen offset:640 sc1
    buffer_load_dwordx4 v[108:111], v3, s[24:27], s50 offen offset:1280 sc1
    buffer_load_dwordx4 v[112:115], v3, s[24:27], s50 offen offset:1920 sc1
    buffer_load_dwordx4 v[116:119], v3, s[24:27], s50 offen offset:2560 sc1
    s_mov_b64 exec, -1
A_MH7b:
    v_lshrrev_b32 v4, 2, v0
    v_mul_u32_u24 v4, 20544, v4
    v_and_b32 v5, 3, v0
    v_lshl_add_u32 v4, v5, 4, v4
    s_mul_i32 s62, s71, 321
    s_lshr_b32 s63, s39, 1
    s_lshl_b32 s63, s63, 5
    s_add_u32 s62, s62, s63
    s_and_b32 s63, s39, 1
    s_add_u32 s62, s62, s63
    s_add_u32 s62, s62, 1
    s_lshl_b32 s62, s62, 1
    s_and_b32 s63, s62, 2
    s_sub_u32 s62, s62, s63
    s_add_u32 s68, s63, s70
    s_mov_b64 s[16:17], s[6:7]
    s_mov_b32 s18, 1314816
    s_mov_b32 s19, 0x20000
    s_mov_b64 s[20:21], s[74:75]
    s_mov_b32 s22, 1314816
    s_mov_b32 s23, 0x20000
    s_add_u32 m0, s70, 0
    s_nop 0
    buffer_load_dwordx4 v4, s[16:19], s62 offen  lds
    s_add_u32 m0, s70, 4096
    s_nop 0
    buffer_load_dwordx4 v4, s[20:23], s62 offen  lds
    s_add_u32 s62, s62, 328704
    s_add_u32 m0, s70, 1024
    s_nop 0
    buffer_load_dwordx4 v4, s[16:19], s62 offen  lds
    s_add_u32 m0, s70, 5120
    s_nop 0
    buffer_load_dwordx4 v4, s[20:23], s62 offen  lds
    s_add_u32 s62, s62, 328704
    s_add_u32 m0, s70, 2048
    s_nop 0
    buffer_load_dwordx4 v4, s[16:19], s62 offen  lds
    s_add_u32 m0, s70, 6144
    s_nop 0
    buffer_load_dwordx4 v4, s[20:23], s62 offen  lds
    s_add_u32 s62, s62, 328704
    s_add_u32 m0, s70, 3072
    s_nop 0
    buffer_load_dwordx4 v4, s[16:19], s62 offen  lds
    s_add_u32 m0, s70, 7168
    s_nop 0
    buffer_load_dwordx4 v4, s[20:23], s62 offen  lds
    s_barrier
    s_waitcnt vmcnt(8)
    s_cmp_eq_u32 s48, 0
    s_cbranch_scc0 A_MH7c
    v_rcp_f32 v5, v225
    v_cvt_pk_bf16_f32 v232, -v224, -v224
    v_mov_b32 v235, v225
    v_mul_f32 v234, 0xc0135761, v5
    v_mul_f32 v5, v5, v5
    v_mul_f32 v5, v5, v234
    v_mul_f32 v233, 0x3d372713, v5
    v_rcp_f32 v5, v227
    v_cvt_pk_bf16_f32 v236, -v226, -v226
    v_mov_b32 v239, v227
    v_mul_f32 v238, 0xc0135761, v5
    v_mul_f32 v5, v5, v5
    v_mul_f32 v5, v5, v238
    v_mul_f32 v237, 0x3d372713, v5
    v_lshlrev_b32 v4, 5, v0
    v_add_u32 v4, 126976, v4
    ds_write_b128 v4, v[232:235]
    ds_write_b128 v4, v[236:239] offset:16
    s_branch A_MH8
A_MH7c:
    s_mov_b32 s69, 0xffff0000
    v_add_f32 v80, v80, v84
    v_add_f32 v81, v81, v85
    v_add_f32 v82, v82, v86
    v_add_f32 v83, v83, v87
    v_add_f32 v80, v80, v88
    v_add_f32 v81, v81, v89
    v_add_f32 v82, v82, v90
    v_add_f32 v83, v83, v91
    v_add_f32 v80, v80, v92
    v_add_f32 v81, v81, v93
    v_add_f32 v82, v82, v94
    v_add_f32 v83, v83, v95
    v_add_f32 v80, v80, v96
    v_add_f32 v81, v81, v97
    v_add_f32 v82, v82, v98
    v_add_f32 v83, v83, v99
    v_add_f32 v80, v80, v100
    v_add_f32 v81, v81, v101
    v_add_f32 v82, v82, v102
    v_add_f32 v83, v83, v103
    v_add_f32 v80, v80, v104
    v_add_f32 v81, v81, v105
    v_add_f32 v82, v82, v106
    v_add_f32 v83, v83, v107
    v_add_f32 v80, v80, v108
    v_add_f32 v81, v81, v109
    v_add_f32 v82, v82, v110
    v_add_f32 v83, v83, v111
    v_add_f32 v80, v80, v112
    v_add_f32 v81, v81, v113
    v_add_f32 v82, v82, v114
    v_add_f32 v83, v83, v115
    v_add_f32 v80, v80, v116
    v_add_f32 v81, v81, v117
    v_add_f32 v82, v82, v118
    v_add_f32 v83, v83, v119
    v_and_b32 v5, s69, v80
    v_sub_f32 v5, v80, v5
    v_cvt_pk_bf16_f32 v5, v5, v5
    v_alignbit_b32 v124, v5, v80, 16
    v_and_b32 v125, 0xffff, v160
    v_and_b32 v5, s69, v81
    v_sub_f32 v5, v81, v5
    v_cvt_pk_bf16_f32 v5, v5, v5
    v_alignbit_b32 v126, v5, v81, 16
    v_lshrrev_b32 v127, 16, v160
    v_and_b32 v5, s69, v82
    v_sub_f32 v5, v82, v5
    v_cvt_pk_bf16_f32 v5, v5, v5
    v_alignbit_b32 v128, v5, v82, 16
    v_and_b32 v129, 0xffff, v161
    v_and_b32 v5, s69, v83
    v_sub_f32 v5, v83, v5
    v_cvt_pk_bf16_f32 v5, v5, v5
    v_alignbit_b32 v130, v5, v83, 16
    v_lshrrev_b32 v131, 16, v161
    v_lshlrev_b32 v4, 5, v0
    v_add_u32 v4, 122880, v4
    s_mov_b32 exec_hi, 0xff
    ds_write_b128 v4, v[124:127]
    ds_write_b128 v4, v[128:131] offset:16
    s_mov_b64 exec, -1
A_MH8:
    s_waitcnt lgkmcnt(0)
    s_barrier
    s_mov_b32 s38, 0
    s_cmp_lt_u32 s55, 40
    s_cbranch_scc1 A_JOB
    s_waitcnt vmcnt(0)
    s_endpgm
A_DH1:
    s_sub_u32 s36, s32, 5
    s_add_u32 s53, s33, 48
    s_lshl_b32 s53, s53, 8
    s_mul_i32 s55, s33, 5
    s_add_u32 s55, s55, s34
    s_mul_i32 s55, s55, 3
    s_add_u32 s55, s55, s36
    s_mul_i32 s38, s36, 10240
    s_add_u32 s38, s38, 129024
    s_lshr_b32 s67, s55, 2
    s_mul_i32 s67, s67, 40960
    s_and_b32 s52, s55, 3
    s_mul_i32 s52, s52, 160
    s_add_u32 s67, s67, s52
    s_mov_b32 s52, 214748365
    v_add_u32 v14, 0, v0
    v_mul_hi_u32 v15, v14, s52
    v_mul_u32_u24 v8, 20, v15
    v_sub_u32 v8, v14, v8
    v_cmp_le_u32 vcc, 10, v8
    v_add_u32 v14, 30, v8
    s_nop 0
    v_cndmask_b32 v8, v8, v14, vcc
    v_mul_u32_u24 v15, 1280, v15
    v_lshl_add_u32 v9, v8, 4, v15
    v_add_u32 v14, 64, v0
    v_mul_hi_u32 v15, v14, s52
    v_mul_u32_u24 v8, 20, v15
    v_sub_u32 v8, v14, v8
    v_cmp_le_u32 vcc, 10, v8
    v_add_u32 v14, 30, v8
    s_nop 0
    v_cndmask_b32 v8, v8, v14, vcc
    v_mul_u32_u24 v15, 1280, v15
    v_lshl_add_u32 v10, v8, 4, v15
    v_subrev_u32 v10, 1024, v10
    v_add_u32 v14, 128, v0
    v_mul_hi_u32 v15, v14, s52
    v_mul_u32_u24 v8, 20, v15
    v_sub_u32 v8, v14, v8
    v_cmp_le_u32 vcc, 10, v8
    v_add_u32 v14, 30, v8
    s_nop 0
    v_cndmask_b32 v8, v8, v14, vcc
    v_mul_u32_u24 v15, 1280, v15
    v_lshl_add_u32 v11, v8, 4, v15
    v_subrev_u32 v11, 2048, v11
    v_add_u32 v14, 192, v0
    v_mul_hi_u32 v15, v14, s52
    v_mul_u32_u24 v8, 20, v15
    v_sub_u32 v8, v14, v8
    v_cmp_le_u32 vcc, 10, v8
    v_add_u32 v14, 30, v8
    s_nop 0
    v_cndmask_b32 v8, v8, v14, vcc
    v_mul_u32_u24 v15, 1280, v15
    v_lshl_add_u32 v12, v8, 4, v15
    v_subrev_u32 v12, 3072, v12
    v_add_u32 v14, 256, v0
    v_mul_hi_u32 v15, v14, s52
    v_mul_u32_u24 v8, 20, v15
    v_sub_u32 v8, v14, v8
    v_cmp_le_u32 vcc, 10, v8
    v_add_u32 v14, 30, v8
    s_nop 0
    v_cndmask_b32 v8, v8, v14, vcc
    v_mul_u32_u24 v15, 1280, v15
    v_lshl_add_u32 v13, v8, 4, v15
    s_mov_b64 s[20:21], s[12:13]
    s_mov_b32 s22, 2211840
    s_mov_b32 s23, 0x20000
    s_and_b32 s54, s32, 3
    s_lshl_b32 s46, s33, 2
    s_add_u32 s46, s46, s54
    v_lshlrev_b32 v14, 8, v2
    v_add_u32 v14, s46, v14
    v_cvt_f32_u32 v14, v14
    v_add_u32 v15, 0, v1
    v_cvt_f32_u32 v15, v15
    v_mul_f32 v15, 0x3a000000, v15
    v_mul_f32 v84, v15, v14
    v_mul_f32 v15, 0x42800000, v15
    v_add_f32 v85, v15, v84
    v_add_f32 v86, v15, v85
    v_add_f32 v87, v15, v86
    v_sin_f32 v88, v84
    v_cos_f32 v84, v84
    v_sin_f32 v89, v85
    v_cos_f32 v85, v85
    v_sin_f32 v90, v86
    v_cos_f32 v86, v86
    v_sin_f32 v91, v87
    v_cos_f32 v87, v87
    v_add_u32 v15, 16, v1
    v_cvt_f32_u32 v15, v15
    v_mul_f32 v15, 0x3a000000, v15
    v_mul_f32 v92, v15, v14
    v_mul_f32 v15, 0x42800000, v15
    v_add_f32 v93, v15, v92
    v_add_f32 v94, v15, v93
    v_add_f32 v95, v15, v94
    v_sin_f32 v96, v92
    v_cos_f32 v92, v92
    v_sin_f32 v97, v93
    v_cos_f32 v93, v93
    v_sin_f32 v98, v94
    v_cos_f32 v94, v94
    v_sin_f32 v99, v95
    v_cos_f32 v95, v95
    s_barrier
    s_cmp_lg_u32 s32, 7
    s_cbranch_scc1 A_D0
    s_load_dword s69, s[72:73], 0
A_D0:
    s_barrier
    s_cmp_lg_u32 s32, 7
    s_cbranch_scc1 A_D1
    s_waitcnt lgkmcnt(0)
    s_cmp_lg_u32 s69, 0
    s_cbranch_scc1 L_8
    s_mov_b32 s61, 50000
    v_mov_b32 v252, 0
L_7:
    s_sleep 8
    global_load_dword v253, v252, s[72:73] sc1
    s_waitcnt vmcnt(0)
    v_readfirstlane_b32 s69, v253
    s_nop 1
    s_cmp_lg_u32 s69, 0
    s_cbranch_scc1 L_8
    s_sub_u32 s61, s61, 1
    s_cmp_lg_u32 s61, 0
    s_cbranch_scc1 L_7
L_8:
    s_sleep 6
    s_mov_b32 s60, 0
    s_atomic_add s60, s[56:57], s53 glc
A_D1:
    s_barrier
    s_cmp_lg_u32 s32, 7
    s_cbranch_scc1 A_D2
    s_mov_b32 s61, 100000
    s_branch L_11
L_9:
    s_mov_b32 s60, 0
    s_atomic_add s60, s[56:57], s53 glc
L_11:
    s_waitcnt lgkmcnt(0)
    s_bfe_u32 s60, s60, 524288
    s_cmp_eq_u32 s60, 16
    s_cbranch_scc1 L_10
    s_sub_u32 s61, s61, 1
    s_cmp_eq_u32 s61, 0
    s_cbranch_scc1 L_10
    s_sleep 2
    s_branch L_9
L_10:
    s_add_u32 s28, s14, 22020096
    s_addc_u32 s29, s15, 0
    s_mov_b32 s30, 16384
    s_mov_b32 s31, 0x20000
    s_lshl_b32 s46, s33, 10
    buffer_load_dwordx4 v[224:227], v3, s[28:31], s46 offen sc1
    s_waitcnt vmcnt(0)
    v_rcp_f32 v224, v225
    v_rcp_f32 v225, v227
    v_lshlrev_b32 v4, 3, v0
    v_add_u32 v4, 126976, v4
    v_mul_f32 v224, 0x35cccccd, v224
    v_mul_f32 v225, 0x35cccccd, v225
    ds_write_b64 v4, v[224:225]
    s_waitcnt lgkmcnt(0)
A_D2:
    s_barrier
A_D3w:
    s_and_b32 s54, s32, 3
    s_lshl_b32 s46, s54, 7
    s_add_u32 s46, s46, 126976
    v_lshl_add_u32 v7, v2, 4, s46
    s_lshl_b32 s46, s54, 12
    s_add_u32 s46, s46, 98304
    v_add_u32 v6, s46, v3
    v_and_b32 v8, 1, v1
    v_lshlrev_b32 v8, 31, v8
    ds_read_b128 v[228:231], v7
    ds_read_b128 v[232:235], v7 offset:64
    s_cmp_eq_u32 s32, 4
    s_cbranch_scc1 A_D2a
    s_add_u32 m0, s38, 0
    s_nop 0
    buffer_load_dwordx4 v9, s[20:23], s67 offen offset:0  lds
    buffer_load_dwordx4 v10, s[20:23], s67 offen offset:1024  lds
    buffer_load_dwordx4 v11, s[20:23], s67 offen offset:2048  lds
    buffer_load_dwordx4 v12, s[20:23], s67 offen offset:3072  lds
    s_add_u32 m0, s38, 4096
    s_nop 0
    buffer_load_dwordx4 v13, s[20:23], s67 offen  lds
    s_add_u32 s67, s67, 20480
    s_add_u32 m0, s38, 5120
    s_nop 0
    buffer_load_dwordx4 v9, s[20:23], s67 offen offset:0  lds
    buffer_load_dwordx4 v10, s[20:23], s67 offen offset:1024  lds
    buffer_load_dwordx4 v11, s[20:23], s67 offen offset:2048  lds
    buffer_load_dwordx4 v12, s[20:23], s67 offen offset:3072  lds
    s_add_u32 m0, s38, 9216
    s_nop 0
    buffer_load_dwordx4 v13, s[20:23], s67 offen  lds
A_D2a:
    s_waitcnt lgkmcnt(0)
    v_xor_b32 v232, v8, v232
    v_xor_b32 v233, v8, v233
    v_xor_b32 v234, v8, v234
    v_xor_b32 v235, v8, v235
    v_mul_f32 v236, v84, v228
    v_mul_f32 v237, v85, v229
    v_mul_f32 v238, v86, v230
    v_mul_f32 v239, v87, v231
    v_mul_f32 v240, v84, v232
    v_mul_f32 v241, v85, v233
    v_mul_f32 v242, v86, v234
    v_mul_f32 v243, v87, v235
    v_cvt_pk_bf16_f32 v104, v236, v237
    v_cvt_pk_bf16_f32 v105, v238, v239
    v_cvt_pk_bf16_f32 v106, v240, v241
    v_cvt_pk_bf16_f32 v107, v242, v243
    ds_write_b128 v6, v[104:107] offset:0
    v_mul_f32 v236, v88, v228
    v_mul_f32 v237, v89, v229
    v_mul_f32 v238, v90, v230
    v_mul_f32 v239, v91, v231
    v_mul_f32 v240, v88, v232
    v_mul_f32 v241, v89, v233
    v_mul_f32 v242, v90, v234
    v_mul_f32 v243, v91, v235
    v_cvt_pk_bf16_f32 v108, v236, v237
    v_cvt_pk_bf16_f32 v109, v238, v239
    v_cvt_pk_bf16_f32 v110, v240, v241
    v_cvt_pk_bf16_f32 v111, v242, v243
    ds_write_b128 v6, v[108:111] offset:1024
    v_mul_f32 v236, v92, v228
    v_mul_f32 v237, v93, v229
    v_mul_f32 v238, v94, v230
    v_mul_f32 v239, v95, v231
    v_mul_f32 v240, v92, v232
    v_mul_f32 v241, v93, v233
    v_mul_f32 v242, v94, v234
    v_mul_f32 v243, v95, v235
    v_cvt_pk_bf16_f32 v112, v236, v237
    v_cvt_pk_bf16_f32 v113, v238, v239
    v_cvt_pk_bf16_f32 v114, v240, v241
    v_cvt_pk_bf16_f32 v115, v242, v243
    ds_write_b128 v6, v[112:115] offset:2048
    v_mul_f32 v236, v96, v228
    v_mul_f32 v237, v97, v229
    v_mul_f32 v238, v98, v230
    v_mul_f32 v239, v99, v231
    v_mul_f32 v240, v96, v232
    v_mul_f32 v241, v97, v233
    v_mul_f32 v242, v98, v234
    v_mul_f32 v243, v99, v235
    v_cvt_pk_bf16_f32 v116, v236, v237
    v_cvt_pk_bf16_f32 v117, v238, v239
    v_cvt_pk_bf16_f32 v118, v240, v241
    v_cvt_pk_bf16_f32 v119, v242, v243
    ds_write_b128 v6, v[116:119] offset:3072
    v_mov_b32 v4, 159744
    v_mov_b32 v5, 1
    s_waitcnt lgkmcnt(0)
    s_mov_b64 exec, 1
    ds_add_u32 v4, v5
    s_mov_b64 exec, -1
    s_cmp_eq_u32 s32, 4
    s_cbranch_scc1 A_D3
    s_cmp_ge_u32 s55, 216
    s_cbranch_scc1 A_D3
    s_add_u32 s24, s14, 8388608
    s_addc_u32 s25, s15, 0
    s_mov_b32 s26, 2211840
    s_mov_b32 s27, 0x20000
    v_lshrrev_b32 v5, 2, v1
    v_lshl_add_u32 v5, v2, 2, v5
    v_mul_u32_u24 v5, 320, v5
    v_and_b32 v6, 3, v1
    v_lshl_add_u32 v5, v6, 3, v5
    v_add_u32 v5, s38, v5
    v_and_b32 v6, 2, v1
    v_mul_u32_u24 v6, 72, v6
    v_add_u32 v7, v5, v6
    v_add_u32 v6, 4096, v3
    s_and_b32 s46, s55, 3
    s_mul_i32 s46, s46, 108
    s_lshr_b32 s52, s55, 2
    s_add_u32 s46, s46, s52
    s_mul_i32 s46, s46, 5120
    s_waitcnt vmcnt(0)
    ds_read_b64_tr_b16 v[184:185], v5 offset:0
    ds_read_b64_tr_b16 v[186:187], v5 offset:5120
    ds_read_b64_tr_b16 v[188:189], v5 offset:32
    ds_read_b64_tr_b16 v[190:191], v5 offset:5152
    ds_read_b64_tr_b16 v[192:193], v7 offset:64
    ds_read_b64_tr_b16 v[194:195], v7 offset:5184
    ds_read_b64_tr_b16 v[196:197], v5 offset:160
    ds_read_b64_tr_b16 v[198:199], v5 offset:5280
    ds_read_b64_tr_b16 v[200:201], v5 offset:192
    ds_read_b64_tr_b16 v[202:203], v5 offset:5312
    ds_read_b64_tr_b16 v[204:205], v5 offset:80
    ds_read_b64_tr_b16 v[206:207], v5 offset:5200
    ds_read_b64_tr_b16 v[208:209], v5 offset:112
    ds_read_b64_tr_b16 v[210:211], v5 offset:5232
    ds_read_b64_tr_b16 v[212:213], v7 offset:144
    ds_read_b64_tr_b16 v[214:215], v7 offset:5264
    ds_read_b64_tr_b16 v[216:217], v5 offset:240
    ds_read_b64_tr_b16 v[218:219], v5 offset:5360
    ds_read_b64_tr_b16 v[220:221], v5 offset:272
    ds_read_b64_tr_b16 v[222:223], v5 offset:5392
    s_waitcnt lgkmcnt(15)
    buffer_store_dwordx4 v[184:187], v3, s[24:27], s46 offen offset:0 sc1
    buffer_store_dwordx4 v[188:191], v3, s[24:27], s46 offen offset:1024 sc1
    s_waitcnt lgkmcnt(14)
    buffer_store_dwordx4 v[192:195], v3, s[24:27], s46 offen offset:2048 sc1
    s_waitcnt lgkmcnt(12)
    buffer_store_dwordx4 v[196:199], v3, s[24:27], s46 offen offset:3072 sc1
    s_waitcnt lgkmcnt(10)
    buffer_store_dwordx4 v[200:203], v6, s[24:27], s46 offen sc1
    s_add_u32 s46, s46, 276480
    s_waitcnt lgkmcnt(8)
    buffer_store_dwordx4 v[204:207], v3, s[24:27], s46 offen offset:0 sc1
    s_waitcnt lgkmcnt(6)
    buffer_store_dwordx4 v[208:211], v3, s[24:27], s46 offen offset:1024 sc1
    s_waitcnt lgkmcnt(4)
    buffer_store_dwordx4 v[212:215], v3, s[24:27], s46 offen offset:2048 sc1
    s_waitcnt lgkmcnt(2)
    buffer_store_dwordx4 v[216:219], v3, s[24:27], s46 offen offset:3072 sc1
    s_waitcnt lgkmcnt(0)
    buffer_store_dwordx4 v[220:223], v6, s[24:27], s46 offen sc1
    s_add_u32 s46, s46, 276480
A_D3:
    s_mul_i32 s46, s43, 12
    s_sub_u32 s39, 8, s47
    s_mul_i32 s39, s39, s44
    s_add_u32 s46, s46, s39
    s_add_u32 s46, s46, s45
    s_sub_u32 s46, s46, s47
    s_mul_i32 s71, s46, 52
    s_lshr_b32 s71, s71, 8
    s_mul_i32 s39, s71, 5
    s_sub_u32 s39, s46, s39
    s_lshl_b32 s39, s39, 2
    s_and_b32 s46, s32, 3
    s_add_u32 s39, s39, s46
    s_mul_i32 s70, s46, 10240
    s_add_u32 s70, s70, 118784
    s_cmp_eq_u32 s46, 0
    s_cselect_b32 s70, 71680, s70
    s_lshl_b32 s46, s42, 3
    s_add_u32 s71, s71, s46
    v_lshrrev_b32 v4, 2, v0
    v_mul_u32_u24 v4, 20544, v4
    v_and_b32 v5, 3, v0
    v_lshl_add_u32 v4, v5, 4, v4
    s_mul_i32 s62, s71, 321
    s_lshr_b32 s63, s39, 1
    s_lshl_b32 s63, s63, 5
    s_add_u32 s62, s62, s63
    s_and_b32 s63, s39, 1
    s_add_u32 s62, s62, s63
    s_add_u32 s62, s62, 1
    s_lshl_b32 s62, s62, 1
    s_and_b32 s63, s62, 2
    s_sub_u32 s62, s62, s63
    s_add_u32 s68, s63, s70
    s_mov_b64 s[16:17], s[6:7]
    s_mov_b32 s18, 1314816
    s_mov_b32 s19, 0x20000
    s_mov_b64 s[20:21], s[74:75]
    s_mov_b32 s22, 1314816
    s_mov_b32 s23, 0x20000
    s_add_u32 m0, s70, 0
    s_nop 0
    buffer_load_dwordx4 v4, s[16:19], s62 offen  lds
    s_add_u32 m0, s70, 4096
    s_nop 0
    buffer_load_dwordx4 v4, s[20:23], s62 offen  lds
    s_add_u32 s62, s62, 328704
    s_add_u32 m0, s70, 1024
    s_nop 0
    buffer_load_dwordx4 v4, s[16:19], s62 offen  lds
    s_add_u32 m0, s70, 5120
    s_nop 0
    buffer_load_dwordx4 v4, s[20:23], s62 offen  lds
    s_add_u32 s62, s62, 328704
    s_add_u32 m0, s70, 2048
    s_nop 0
    buffer_load_dwordx4 v4, s[16:19], s62 offen  lds
    s_add_u32 m0, s70, 6144
    s_nop 0
    buffer_load_dwordx4 v4, s[20:23], s62 offen  lds
    s_add_u32 s62, s62, 328704
    s_add_u32 m0, s70, 3072
    s_nop 0
    buffer_load_dwordx4 v4, s[16:19], s62 offen  lds
    s_add_u32 m0, s70, 7168
    s_nop 0
    buffer_load_dwordx4 v4, s[20:23], s62 offen  lds
    s_cmp_eq_u32 s32, 4
    s_cbranch_scc1 A_DH
    s_cmp_ge_u32 s55, 216
    s_cbranch_scc1 A_DW
    s_and_b32 s46, s55, 7
    s_add_u32 s46, s46, 40
    s_lshl_b32 s46, s46, 8
    s_mov_b32 s66, 1
    s_waitcnt vmcnt(0)
    s_atomic_add s66, s[56:57], s46 glc
    v_lshlrev_b32 v4, 8, v0
    v_mov_b32 v5, 65536
    s_movk_i32 s46, 20480
    s_waitcnt lgkmcnt(0)
    s_cmp_lg_u32 s66, 26
    s_cbranch_scc1 L_12
    buffer_atomic_add v5, v4, s[56:59], s46 offen sc1
L_12:
    s_branch A_DW
A_DH0:
    s_waitcnt lgkmcnt(0)
    s_add_u32 s56, s14, 20971520
    s_addc_u32 s57, s15, 0
    s_mov_b32 s58, 28672
    s_mov_b32 s59, 0x20000
    s_mov_b64 s[16:17], s[4:5]
    s_mov_b32 s18, 2621440
    s_mov_b32 s19, 0x20000
    s_and_b32 s46, s32, 1
    s_xor_b32 s46, s46, 1
    s_mul_i32 s46, s46, 11
    s_add_u32 s36, s46, s34
    s_cmp_ge_u32 s45, s47
    s_cselect_b32 s36, 99, s36
    s_cmp_ge_u32 s36, 16
    s_cbranch_scc1 A_DH
    s_and_b32 s46, s36, 3
    s_lshl_b32 s46, s46, 9
    s_lshr_b32 s52, s36, 2
    s_add_u32 s46, s46, s52
    s_lshl_b32 s52, s33, 2
    s_add_u32 s46, s46, s52
    s_mul_i32 s46, s46, 1280
    v_lshrrev_b32 v4, 3, v0
    v_mul_u32_u24 v4, 81920, v4
    v_and_b32 v5, 7, v0
    v_lshl_add_u32 v4, v5, 4, v4
    buffer_load_dwordx4 v[212:215], v4, s[16:19], s46 offen offset:0
    buffer_load_dwordx4 v[216:219], v4, s[16:19], s46 offen offset:128
    buffer_load_dwordx4 v[220:223], v4, s[16:19], s46 offen offset:256
    buffer_load_dwordx4 v[224:227], v4, s[16:19], s46 offen offset:384
    buffer_load_dwordx4 v[228:231], v4, s[16:19], s46 offen offset:512
    buffer_load_dwordx4 v[232:235], v4, s[16:19], s46 offen offset:640
    buffer_load_dwordx4 v[236:239], v4, s[16:19], s46 offen offset:768
    buffer_load_dwordx4 v[240:243], v4, s[16:19], s46 offen offset:896
    buffer_load_dwordx4 v[244:247], v4, s[16:19], s46 offen offset:1024
    buffer_load_dwordx4 v[248:251], v4, s[16:19], s46 offen offset:1152
A_DH:
    v_lshlrev_b32 v5, 2, v2
    v_cvt_f32_u32 v5, v5
    v_cvt_f32_u32 v6, v1
    v_mul_f32 v6, 0x3c800000, v6
    v_mul_f32 v7, v6, v5
    v_fmamk_f32 v192, v6, 0x00000000, v7
    v_fmamk_f32 v193, v6, 0x3f800000, v7
    v_fmamk_f32 v194, v6, 0x40000000, v7
    v_fmamk_f32 v195, v6, 0x40400000, v7
    v_fmamk_f32 v196, v6, 0x41800000, v7
    v_fmamk_f32 v197, v6, 0x41880000, v7
    v_fmamk_f32 v198, v6, 0x41900000, v7
    v_fmamk_f32 v199, v6, 0x41980000, v7
    v_sin_f32 v200, v192
    v_cos_f32 v192, v192
    v_sin_f32 v201, v193
    v_cos_f32 v193, v193
    v_sin_f32 v202, v194
    v_cos_f32 v194, v194
    v_sin_f32 v203, v195
    v_cos_f32 v195, v195
    v_sin_f32 v204, v196
    v_cos_f32 v196, v196
    v_sin_f32 v205, v197
    v_cos_f32 v197, v197
    v_sin_f32 v206, v198
    v_cos_f32 v198, v198
    v_sin_f32 v207, v199
    v_cos_f32 v199, v199
    s_brev_b32 s67, 1
    v_cvt_pk_bf16_f32 v16, v192, v193
    v_cvt_pk_bf16_f32 v48, v200, v201
    v_cvt_pk_bf16_f32 v24, v192, -v201
    v_cvt_pk_bf16_f32 v56, v200, v193
    v_cvt_pk_bf16_f32 v17, v194, v195
    v_cvt_pk_bf16_f32 v49, v202, v203
    v_cvt_pk_bf16_f32 v25, -v194, v203
    v_cvt_pk_bf16_f32 v57, -v202, -v195
    v_cvt_pk_bf16_f32 v18, v196, v197
    v_cvt_pk_bf16_f32 v50, v204, v205
    v_cvt_pk_bf16_f32 v26, v196, -v205
    v_cvt_pk_bf16_f32 v58, v204, v197
    v_cvt_pk_bf16_f32 v19, v198, v199
    v_cvt_pk_bf16_f32 v51, v206, v207
    v_cvt_pk_bf16_f32 v27, -v198, v207
    v_cvt_pk_bf16_f32 v59, -v206, -v199
    v_and_b32 v5, 1, v1
    v_mul_u32_u24 v5, 0x8000, v5
    v_lshl_or_b32 v5, v5, 16, v5
    v_xor_b32 v32, s67, v16
    v_xor_b32 v33, s67, v17
    v_xor_b32 v34, s67, v18
    v_xor_b32 v35, s67, v19
    v_xor_b32 v40, s67, v24
    v_xor_b32 v41, s67, v25
    v_xor_b32 v42, s67, v26
    v_xor_b32 v43, s67, v27
    v_xor_b32 v20, v5, v16
    v_xor_b32 v21, v5, v17
    v_xor_b32 v22, v5, v18
    v_xor_b32 v23, v5, v19
    v_xor_b32 v28, v5, v24
    v_xor_b32 v29, v5, v25
    v_xor_b32 v30, v5, v26
    v_xor_b32 v31, v5, v27
    v_xor_b32 v36, v5, v32
    v_xor_b32 v37, v5, v33
    v_xor_b32 v38, v5, v34
    v_xor_b32 v39, v5, v35
    v_xor_b32 v44, v5, v40
    v_xor_b32 v45, v5, v41
    v_xor_b32 v46, v5, v42
    v_xor_b32 v47, v5, v43
    v_xor_b32 v64, s67, v48
    v_xor_b32 v65, s67, v49
    v_xor_b32 v66, s67, v50
    v_xor_b32 v67, s67, v51
    v_xor_b32 v72, s67, v56
    v_xor_b32 v73, s67, v57
    v_xor_b32 v74, s67, v58
    v_xor_b32 v75, s67, v59
    v_xor_b32 v52, v5, v48
    v_xor_b32 v53, v5, v49
    v_xor_b32 v54, v5, v50
    v_xor_b32 v55, v5, v51
    v_xor_b32 v60, v5, v56
    v_xor_b32 v61, v5, v57
    v_xor_b32 v62, v5, v58
    v_xor_b32 v63, v5, v59
    v_xor_b32 v68, v5, v64
    v_xor_b32 v69, v5, v65
    v_xor_b32 v70, v5, v66
    v_xor_b32 v71, v5, v67
    v_xor_b32 v76, v5, v72
    v_xor_b32 v77, v5, v73
    v_xor_b32 v78, v5, v74
    v_xor_b32 v79, v5, v75
    s_cmp_lt_u32 s45, s47
    s_cbranch_scc1 A_MH
    s_cmp_gt_u32 s32, 4
    s_cbranch_scc1 A_DH1
A_DW:
    s_mov_b32 s38, 0
A_JOB:
    s_setprio 3
    s_add_u32 s28, s14, 12582912
    s_addc_u32 s29, s15, 0
    s_mov_b32 s30, 2621440
    s_mov_b32 s31, 0x20000
    s_add_u32 s24, s14, 16777216
    s_addc_u32 s25, s15, 0
    s_mov_b32 s26, 2621440
    s_mov_b32 s27, 0x20000
    v_mov_b32 v80, 0
    v_mov_b32 v81, 0
    v_mov_b32 v82, 0
    v_mov_b32 v83, 0
    v_mov_b32 v84, 0
    v_mov_b32 v85, 0
    v_mov_b32 v86, 0
    v_mov_b32 v87, 0
    v_mov_b32 v88, 0
    v_mov_b32 v89, 0
    v_mov_b32 v90, 0
    v_mov_b32 v91, 0
    v_mov_b32 v92, 0
    v_mov_b32 v93, 0
    v_mov_b32 v94, 0
    v_mov_b32 v95, 0
    v_mov_b32 v96, 0
    v_mov_b32 v97, 0
    v_mov_b32 v98, 0
    v_mov_b32 v99, 0
    v_mov_b32 v100, 0
    v_mov_b32 v101, 0
    v_mov_b32 v102, 0
    v_mov_b32 v103, 0
    v_mov_b32 v104, 0
    v_mov_b32 v105, 0
    v_mov_b32 v106, 0
    v_mov_b32 v107, 0
    v_mov_b32 v108, 0
    v_mov_b32 v109, 0
    v_mov_b32 v110, 0
    v_mov_b32 v111, 0
    v_lshrrev_b32 v5, 2, v1
    v_lshl_add_u32 v5, v2, 2, v5
    v_lshlrev_b32 v5, 6, v5
    v_and_b32 v6, 3, v1
    v_lshl_add_u32 v5, v6, 4, v5
    v_add_u32 v5, s70, v5
    v_lshlrev_b32 v6, 8, v2
    v_lshl_add_u32 v6, v1, 2, v6
    v_add_u32 v6, s68, v6
    s_mov_b32 s65, 0x80008000
    s_mul_i32 s50, s71, 20
    s_add_u32 s50, s50, s39
    s_lshl_b32 s50, s50, 12
    s_lshl_b32 s51, s39, 8
    s_mov_b32 m0, s70
    s_waitcnt vmcnt(0)
    ds_read_u16_d16_hi v80, v6 offset:0
    ds_read_u16_d16_hi v96, v6 offset:4096
    ds_read_u16_d16_hi v81, v6 offset:64
    ds_read_u16_d16_hi v97, v6 offset:4160
    ds_read_u16_d16_hi v82, v6 offset:128
    ds_read_u16_d16_hi v98, v6 offset:4224
    ds_read_u16_d16_hi v83, v6 offset:192
    ds_read_u16_d16_hi v99, v6 offset:4288
    ds_read_u16_d16_hi v84, v6 offset:1024
    ds_read_u16_d16_hi v100, v6 offset:5120
    ds_read_u16_d16_hi v85, v6 offset:1088
    ds_read_u16_d16_hi v101, v6 offset:5184
    ds_read_u16_d16_hi v86, v6 offset:1152
    ds_read_u16_d16_hi v102, v6 offset:5248
    ds_read_u16_d16_hi v87, v6 offset:1216
    ds_read_u16_d16_hi v103, v6 offset:5312
    ds_read_u16_d16_hi v88, v6 offset:2048
    ds_read_u16_d16_hi v104, v6 offset:6144
    ds_read_u16_d16_hi v89, v6 offset:2112
    ds_read_u16_d16_hi v105, v6 offset:6208
    ds_read_u16_d16_hi v90, v6 offset:2176
    ds_read_u16_d16_hi v106, v6 offset:6272
    ds_read_u16_d16_hi v91, v6 offset:2240
    ds_read_u16_d16_hi v107, v6 offset:6336
    ds_read_u16_d16_hi v92, v6 offset:3072
    ds_read_u16_d16_hi v108, v6 offset:7168
    ds_read_u16_d16_hi v93, v6 offset:3136
    ds_read_u16_d16_hi v109, v6 offset:7232
    ds_read_u16_d16_hi v94, v6 offset:3200
    ds_read_u16_d16_hi v110, v6 offset:7296
    ds_read_u16_d16_hi v95, v6 offset:3264
    ds_read_u16_d16_hi v111, v6 offset:7360
    s_cmp_lt_u32 s45, s47
    s_cbranch_scc1 A_J1
    v_mov_b32 v10, 159744
    s_mov_b32 s61, 4000000
L_13:
    ds_read_b32 v11, v10
    s_waitcnt lgkmcnt(0)
    v_readfirstlane_b32 s60, v11
    s_nop 1
    s_bfe_u32 s60, s60, 524288
    s_cmp_ge_u32 s60, 12
    s_cbranch_scc1 L_14
    s_sub_u32 s61, s61, 1
    s_cmp_lg_u32 s61, 0
    s_sleep 1
    s_cbranch_scc1 L_13
L_14:
    s_branch A_J1b
A_J1:
A_J1b:
    s_mov_b32 s61, 100000
L_15:
    s_mov_b32 s60, 0
    s_atomic_add s60, s[56:57], s51 glc
L_17:
    s_waitcnt lgkmcnt(0)
    s_bfe_u32 s60, s60, 524288
    s_cmp_eq_u32 s60, 16
    s_cbranch_scc1 L_16
    s_sub_u32 s61, s61, 1
    s_cmp_eq_u32 s61, 0
    s_cbranch_scc1 L_16
    s_sleep 2
    s_branch L_15
L_16:
    buffer_load_dwordx4 v3, s[28:31], s50 offen offset:0 sc1 lds
    buffer_load_dwordx4 v3, s[28:31], s50 offen offset:1024 sc1 lds
    buffer_load_dwordx4 v3, s[28:31], s50 offen offset:2048 sc1 lds
    buffer_load_dwordx4 v3, s[28:31], s50 offen offset:3072 sc1 lds
    v_lshrrev_b32 v9, 1, v1
    v_and_b32 v9, 3, v9
    v_xor_b32 v9, v9, v2
    v_lshlrev_b32 v9, 4, v9
    v_lshl_add_u32 v9, v1, 6, v9
    v_add_u32 v9, s70, v9
    v_lshrrev_b32 v6, 3, v0
    v_and_b32 v7, 3, v6
    v_lshlrev_b32 v7, 4, v7
    v_xor_b32 v7, v7, v3
    v_add_u32 v7, s70, v7
    v_mul_u32_u24 v6, 81920, v6
    v_and_b32 v8, 7, v0
    v_lshl_add_u32 v6, v8, 4, v6
    s_lshl_b32 s50, s39, 12
    s_lshl_b32 s46, s71, 7
    s_add_u32 s50, s50, s46
    s_cmp_eq_u32 s39, 19
    s_cselect_b32 s46, 0.5, 1.0
    v_cmp_eq_u32 vcc, 3, v2
    v_mov_b32 v8, s46
    s_nop 0
    v_cndmask_b32 v8, 1.0, v8, vcc
    s_waitcnt vmcnt(0)
    v_mov_b32 v10, 159744
    s_mov_b32 s61, 4000000
L_18:
    ds_read_b32 v11, v10
    s_waitcnt lgkmcnt(0)
    v_readfirstlane_b32 s60, v11
    s_nop 1
    s_bfe_u32 s60, s60, 524288
    s_cmp_ge_u32 s60, s38
    s_cbranch_scc1 L_19
    s_sub_u32 s61, s61, 1
    s_cmp_lg_u32 s61, 0
    s_sleep 1
    s_cbranch_scc1 L_18
L_19:
    ds_read_b64_tr_b16 v[144:145], v5 offset:0
    ds_read_b64_tr_b16 v[146:147], v5 offset:1024
    ds_read_b64_tr_b16 v[148:149], v5 offset:8
    ds_read_b64_tr_b16 v[150:151], v5 offset:1032
    ds_read_b64_tr_b16 v[156:157], v5 offset:2048
    ds_read_b64_tr_b16 v[158:159], v5 offset:3072
    ds_read_b64_tr_b16 v[160:161], v5 offset:2056
    ds_read_b64_tr_b16 v[162:163], v5 offset:3080
    s_waitcnt lgkmcnt(7)
    v_xor_b32 v152, s65, v144
    v_xor_b32 v153, s65, v145
    s_waitcnt lgkmcnt(6)
    v_xor_b32 v154, s65, v146
    v_xor_b32 v155, s65, v147
    s_waitcnt lgkmcnt(3)
    v_xor_b32 v164, s65, v156
    v_xor_b32 v165, s65, v157
    s_waitcnt lgkmcnt(2)
    v_xor_b32 v166, s65, v158
    v_xor_b32 v167, s65, v159
    v_mfma_f32_16x16x32_bf16 v[112:115], v[16:19], v[144:147], 0
    v_mfma_f32_16x16x32_bf16 v[116:119], v[16:19], v[148:151], 0
    v_mfma_f32_16x16x32_bf16 v[112:115], v[48:51], v[148:151], v[112:115]
    v_mfma_f32_16x16x32_bf16 v[116:119], v[48:51], v[152:155], v[116:119]
    v_mfma_f32_16x16x32_bf16 v[112:115], v[20:23], v[156:159], v[112:115]
    s_waitcnt lgkmcnt(0)
    v_mfma_f32_16x16x32_bf16 v[116:119], v[20:23], v[160:163], v[116:119]
    v_mfma_f32_16x16x32_bf16 v[112:115], v[52:55], v[160:163], v[112:115]
    v_mfma_f32_16x16x32_bf16 v[116:119], v[52:55], v[164:167], v[116:119]
    v_mfma_f32_16x16x32_bf16 v[120:123], v[24:27], v[144:147], 0
    v_mfma_f32_16x16x32_bf16 v[124:127], v[24:27], v[148:151], 0
    v_mfma_f32_16x16x32_bf16 v[120:123], v[56:59], v[148:151], v[120:123]
    v_mfma_f32_16x16x32_bf16 v[124:127], v[56:59], v[152:155], v[124:127]
    v_mfma_f32_16x16x32_bf16 v[120:123], v[28:31], v[156:159], v[120:123]
    s_nop 2
    v_mul_f32 v168, v116, v96
    v_mul_f32 v172, v112, v96
    v_fma_f32 v168, v112, v80, -v168
    v_mfma_f32_16x16x32_bf16 v[124:127], v[28:31], v[160:163], v[124:127]
    v_fmac_f32 v172, v116, v80
    v_mul_f32 v169, v117, v97
    v_mfma_f32_16x16x32_bf16 v[120:123], v[60:63], v[160:163], v[120:123]
    v_mul_f32 v173, v113, v97
    v_fma_f32 v169, v113, v81, -v169
    v_mfma_f32_16x16x32_bf16 v[124:127], v[60:63], v[164:167], v[124:127]
    v_fmac_f32 v173, v117, v81
    v_mul_f32 v170, v118, v98
    v_mfma_f32_16x16x32_bf16 v[128:131], v[32:35], v[144:147], 0
    v_mul_f32 v174, v114, v98
    v_fma_f32 v170, v114, v82, -v170
    v_mfma_f32_16x16x32_bf16 v[132:135], v[32:35], v[148:151], 0
    v_fmac_f32 v174, v118, v82
    v_mul_f32 v171, v119, v99
    v_mul_f32 v175, v115, v99
    v_mfma_f32_16x16x32_bf16 v[128:131], v[64:67], v[148:151], v[128:131]
    v_fma_f32 v171, v115, v83, -v171
    v_fmac_f32 v175, v119, v83
    v_mfma_f32_16x16x32_bf16 v[132:135], v[64:67], v[152:155], v[132:135]
    v_cvt_pk_bf16_f32 v184, v168, v169
    v_cvt_pk_bf16_f32 v188, v172, v173
    v_mfma_f32_16x16x32_bf16 v[128:131], v[36:39], v[156:159], v[128:131]
    v_xor_b32 v192, s65, v188
    v_cvt_pk_bf16_f32 v185, v170, v171
    v_mfma_f32_16x16x32_bf16 v[132:135], v[36:39], v[160:163], v[132:135]
    v_cvt_pk_bf16_f32 v189, v174, v175
    v_xor_b32 v193, s65, v189
    v_mfma_f32_16x16x32_bf16 v[128:131], v[68:71], v[160:163], v[128:131]
    v_mul_f32 v176, v124, v100
    v_mul_f32 v180, v120, v100
    v_fma_f32 v176, v120, v84, -v176
    v_mfma_f32_16x16x32_bf16 v[132:135], v[68:71], v[164:167], v[132:135]
    v_fmac_f32 v180, v124, v84
    v_mul_f32 v177, v125, v101
    v_mfma_f32_16x16x32_bf16 v[136:139], v[40:43], v[144:147], 0
    v_mul_f32 v181, v121, v101
    v_fma_f32 v177, v121, v85, -v177
    v_mfma_f32_16x16x32_bf16 v[140:143], v[40:43], v[148:151], 0
    v_fmac_f32 v181, v125, v85
    v_mul_f32 v178, v126, v102
    v_mfma_f32_16x16x32_bf16 v[136:139], v[72:75], v[148:151], v[136:139]
    v_mul_f32 v182, v122, v102
    v_fma_f32 v178, v122, v86, -v178
    v_mfma_f32_16x16x32_bf16 v[140:143], v[72:75], v[152:155], v[140:143]
    v_fmac_f32 v182, v126, v86
    v_mul_f32 v179, v127, v103
    v_mul_f32 v183, v123, v103
    v_mfma_f32_16x16x32_bf16 v[136:139], v[44:47], v[156:159], v[136:139]
    v_fma_f32 v179, v123, v87, -v179
    v_fmac_f32 v183, v127, v87
    v_mfma_f32_16x16x32_bf16 v[140:143], v[44:47], v[160:163], v[140:143]
    v_cvt_pk_bf16_f32 v186, v176, v177
    v_cvt_pk_bf16_f32 v190, v180, v181
    v_mfma_f32_16x16x32_bf16 v[136:139], v[76:79], v[160:163], v[136:139]
    v_xor_b32 v194, s65, v190
    v_cvt_pk_bf16_f32 v187, v178, v179
    v_mfma_f32_16x16x32_bf16 v[140:143], v[76:79], v[164:167], v[140:143]
    v_cvt_pk_bf16_f32 v191, v182, v183
    v_xor_b32 v195, s65, v191
    v_mfma_f32_16x16x32_bf16 v[208:211], v[184:187], v[16:19], 0
    v_mul_f32 v168, v132, v104
    v_mul_f32 v172, v128, v104
    v_fma_f32 v168, v128, v88, -v168
    v_mfma_f32_16x16x32_bf16 v[212:215], v[188:191], v[16:19], 0
    v_fmac_f32 v172, v132, v88
    v_mul_f32 v169, v133, v105
    v_mul_f32 v173, v129, v105
    v_mfma_f32_16x16x32_bf16 v[208:211], v[192:195], v[48:51], v[208:211]
    v_fma_f32 v169, v129, v89, -v169
    v_fmac_f32 v173, v133, v89
    v_mul_f32 v170, v134, v106
    v_mfma_f32_16x16x32_bf16 v[212:215], v[184:187], v[48:51], v[212:215]
    v_mul_f32 v174, v130, v106
    v_fma_f32 v170, v130, v90, -v170
    v_mfma_f32_16x16x32_bf16 v[216:219], v[184:187], v[24:27], 0
    v_fmac_f32 v174, v134, v90
    v_mul_f32 v171, v135, v107
    v_mul_f32 v175, v131, v107
    v_mfma_f32_16x16x32_bf16 v[220:223], v[188:191], v[24:27], 0
    v_fma_f32 v171, v131, v91, -v171
    v_fmac_f32 v175, v135, v91
    v_cvt_pk_bf16_f32 v196, v168, v169
    v_mfma_f32_16x16x32_bf16 v[216:219], v[192:195], v[56:59], v[216:219]
    v_cvt_pk_bf16_f32 v200, v172, v173
    v_xor_b32 v204, s65, v200
    v_cvt_pk_bf16_f32 v197, v170, v171
    v_mfma_f32_16x16x32_bf16 v[220:223], v[184:187], v[56:59], v[220:223]
    v_cvt_pk_bf16_f32 v201, v174, v175
    v_xor_b32 v205, s65, v201
    v_mfma_f32_16x16x32_bf16 v[224:227], v[184:187], v[32:35], 0
    v_mul_f32 v176, v140, v108
    v_mul_f32 v180, v136, v108
    v_fma_f32 v176, v136, v92, -v176
    v_mfma_f32_16x16x32_bf16 v[228:231], v[188:191], v[32:35], 0
    v_fmac_f32 v180, v140, v92
    v_mul_f32 v177, v141, v109
    v_mul_f32 v181, v137, v109
    v_mfma_f32_16x16x32_bf16 v[224:227], v[192:195], v[64:67], v[224:227]
    v_fma_f32 v177, v137, v93, -v177
    v_fmac_f32 v181, v141, v93
    v_mul_f32 v178, v142, v110
    v_mfma_f32_16x16x32_bf16 v[228:231], v[184:187], v[64:67], v[228:231]
    v_mul_f32 v182, v138, v110
    v_fma_f32 v178, v138, v94, -v178
    v_mfma_f32_16x16x32_bf16 v[232:235], v[184:187], v[40:43], 0
    v_fmac_f32 v182, v142, v94
    v_mul_f32 v179, v143, v111
    v_mul_f32 v183, v139, v111
    v_mfma_f32_16x16x32_bf16 v[236:239], v[188:191], v[40:43], 0
    v_fma_f32 v179, v139, v95, -v179
    v_fmac_f32 v183, v143, v95
    v_cvt_pk_bf16_f32 v198, v176, v177
    v_mfma_f32_16x16x32_bf16 v[232:235], v[192:195], v[72:75], v[232:235]
    v_cvt_pk_bf16_f32 v202, v180, v181
    v_xor_b32 v206, s65, v202
    v_cvt_pk_bf16_f32 v199, v178, v179
    v_mfma_f32_16x16x32_bf16 v[236:239], v[184:187], v[72:75], v[236:239]
    v_cvt_pk_bf16_f32 v203, v182, v183
    v_xor_b32 v207, s65, v203
    v_mfma_f32_16x16x32_bf16 v[208:211], v[196:199], v[20:23], v[208:211]
    v_mfma_f32_16x16x32_bf16 v[212:215], v[200:203], v[20:23], v[212:215]
    v_mfma_f32_16x16x32_bf16 v[208:211], v[204:207], v[52:55], v[208:211]
    v_mfma_f32_16x16x32_bf16 v[212:215], v[196:199], v[52:55], v[212:215]
    v_mfma_f32_16x16x32_bf16 v[216:219], v[196:199], v[28:31], v[216:219]
    v_mfma_f32_16x16x32_bf16 v[220:223], v[200:203], v[28:31], v[220:223]
    v_mfma_f32_16x16x32_bf16 v[216:219], v[204:207], v[60:63], v[216:219]
    v_mfma_f32_16x16x32_bf16 v[220:223], v[196:199], v[60:63], v[220:223]
    v_mfma_f32_16x16x32_bf16 v[224:227], v[196:199], v[36:39], v[224:227]
    v_mfma_f32_16x16x32_bf16 v[228:231], v[200:203], v[36:39], v[228:231]
    s_nop 0
    v_mul_f32 v211, v211, v8
    v_mul_f32 v215, v215, v8
    v_mfma_f32_16x16x32_bf16 v[224:227], v[204:207], v[68:71], v[224:227]
    v_cvt_pk_bf16_f32 v168, v208, v209
    v_cvt_pk_bf16_f32 v169, v210, v211
    v_mfma_f32_16x16x32_bf16 v[228:231], v[196:199], v[68:71], v[228:231]
    v_cvt_pk_bf16_f32 v170, v212, v213
    v_cvt_pk_bf16_f32 v171, v214, v215
    v_mfma_f32_16x16x32_bf16 v[232:235], v[196:199], v[44:47], v[232:235]
    ds_write_b128 v9, v[168:171] offset:0
    v_mul_f32 v219, v219, v8
    v_mfma_f32_16x16x32_bf16 v[236:239], v[200:203], v[44:47], v[236:239]
    v_mul_f32 v223, v223, v8
    v_cvt_pk_bf16_f32 v172, v216, v217
    v_mfma_f32_16x16x32_bf16 v[232:235], v[204:207], v[76:79], v[232:235]
    v_cvt_pk_bf16_f32 v173, v218, v219
    v_cvt_pk_bf16_f32 v174, v220, v221
    v_mfma_f32_16x16x32_bf16 v[236:239], v[196:199], v[76:79], v[236:239]
    v_cvt_pk_bf16_f32 v175, v222, v223
    ds_write_b128 v9, v[172:175] offset:1024
    v_mul_f32 v227, v227, v8
    v_mul_f32 v231, v231, v8
    v_cvt_pk_bf16_f32 v176, v224, v225
    v_cvt_pk_bf16_f32 v177, v226, v227
    v_cvt_pk_bf16_f32 v178, v228, v229
    v_cvt_pk_bf16_f32 v179, v230, v231
    ds_write_b128 v9, v[176:179] offset:2048
    v_mul_f32 v235, v235, v8
    v_mul_f32 v239, v239, v8
    v_cvt_pk_bf16_f32 v180, v232, v233
    v_cvt_pk_bf16_f32 v181, v234, v235
    v_cvt_pk_bf16_f32 v182, v236, v237
    v_cvt_pk_bf16_f32 v183, v238, v239
    ds_write_b128 v9, v[180:183] offset:3072
    s_waitcnt lgkmcnt(0)
    ds_read_b128 v[144:147], v7 offset:0
    ds_read_b128 v[148:151], v7 offset:1024
    ds_read_b128 v[152:155], v7 offset:2048
    ds_read_b128 v[156:159], v7 offset:3072
    s_waitcnt lgkmcnt(3)
    buffer_store_dwordx4 v[144:147], v6, s[24:27], s50 offen sc1
    s_add_u32 s50, s50, 655360
    s_waitcnt lgkmcnt(2)
    buffer_store_dwordx4 v[148:151], v6, s[24:27], s50 offen sc1
    s_add_u32 s50, s50, 655360
    s_waitcnt lgkmcnt(1)
    buffer_store_dwordx4 v[152:155], v6, s[24:27], s50 offen sc1
    s_add_u32 s50, s50, 655360
    s_waitcnt lgkmcnt(0)
    buffer_store_dwordx4 v[156:159], v6, s[24:27], s50 offen sc1
    s_add_u32 s50, s50, 655360
    s_mov_b32 s55, 0
    s_cmp_lt_u32 s32, 9
    s_cbranch_scc1 A_J2
    v_mov_b32 v4, 159744
    ds_read_b32 v5, v4
    s_waitcnt lgkmcnt(0)
    v_readfirstlane_b32 s55, v5
    s_nop 1
    s_bfe_u32 s55, s55, 524296
    s_cmp_eq_u32 s55, 0
    s_cbranch_scc1 A_J2
    s_barrier
    s_barrier
    s_barrier
A_J2:
    s_add_u32 s46, s39, 20
    s_lshl_b32 s46, s46, 8
    s_mov_b32 s66, 1
    s_waitcnt vmcnt(0)
    s_atomic_add s66, s[56:57], s46 glc
    s_cmp_eq_u32 s55, 0
    s_cbranch_scc1 A_J3
    s_barrier
    s_barrier
A_J3:
    v_lshlrev_b32 v4, 8, v0
    v_mov_b32 v5, 256
    s_movk_i32 s46, 20480
    s_waitcnt lgkmcnt(0)
    s_cmp_lg_u32 s66, 31
    s_cbranch_scc1 A_J4
    buffer_atomic_add v5, v4, s[56:59], s46 offen sc1
A_J4:
    s_cmp_eq_u32 s32, 4
    s_cbranch_scc1 B_LH
    s_cmp_eq_u32 s32, 5
    s_cbranch_scc1 B_LW
    s_endpgm
A_COMPUTE:
    s_lshl_b32 s36, s33, 2
    s_add_u32 s36, s36, s32
    v_lshrrev_b32 v8, 1, v1
    v_xor_b32 v8, v8, v2
    v_lshlrev_b32 v8, 4, v8
    v_lshl_add_u32 v8, v1, 7, v8
    s_mov_b32 s50, 0
    s_waitcnt lgkmcnt(0)
    s_cmp_ge_u32 s45, s47
    s_cbranch_scc1 A_DFT
    s_mov_b64 s[20:21], s[14:15]
    s_mov_b32 s22, 7077888
    s_mov_b32 s23, 0x20000
    v_lshrrev_b32 v15, 2, v1
    v_lshl_add_u32 v15, v2, 3, v15
    v_mul_u32_u24 v15, 320, v15
    v_and_b32 v18, 3, v1
    v_lshl_add_u32 v15, v18, 3, v15
    v_add_u32 v15, 16384, v15
    v_and_b32 v16, 1, v2
    v_lshlrev_b32 v16, 5, v16
    s_lshl_b32 s46, s32, 12
    v_add_u32 v14, s46, v8
    v_lshlrev_b32 v18, 3, v1
    v_add_u32 v18, 122880, v18
    s_lshl_b32 s46, s32, 9
    s_add_u32 s46, s46, 126976
    v_lshl_add_u32 v9, v1, 4, s46
    s_lshr_b32 s38, s36, 1
    s_mul_i32 s46, s38, 54
    s_lshr_b32 s52, s37, 5
    s_add_u32 s46, s46, s52
    s_lshl_b32 s46, s46, 2
    s_and_b32 s52, s36, 1
    s_lshl_b32 s52, s52, 1
    s_add_u32 s46, s46, s52
    s_lshl_b32 s57, s46, 10
    s_cmp_eq_u32 s34, 10
    s_cselect_b32 s58, 0x40000000, s57
    s_add_u32 s38, s38, 80
    v_cmp_eq_u32 s[64:65], 0, v2
    s_mov_b32 s54, 10
    v_mov_b32 v4, 0
    v_mov_b32 v5, 0
    v_mov_b32 v6, 0
    v_mov_b32 v7, 0
    s_nop 1
    v_mfma_f32_32x32x16_bf16 v[20:35], v[4:7], v[4:7], 0
    v_mfma_f32_32x32x16_bf16 v[36:51], v[4:7], v[4:7], 0
    v_mfma_f32_32x32x16_bf16 v[52:67], v[4:7], v[4:7], 0
    v_mfma_f32_32x32x16_bf16 v[68:83], v[4:7], v[4:7], 0
    v_mfma_f32_32x32x16_bf16 v[84:99], v[4:7], v[4:7], 0
    v_mfma_f32_32x32x16_bf16 v[196:211], v[4:7], v[4:7], 0
    v_mfma_f32_32x32x16_bf16 v[212:227], v[4:7], v[4:7], 0
    v_mfma_f32_32x32x16_bf16 v[228:243], v[4:7], v[4:7], 0
    v_add_u32 v10, s50, v14
    v_add_u32 v13, s50, v15
    v_add_u32 v12, v13, v16
    v_sub_u32 v13, v13, v16
    v_xor_b32 v11, 64, v10
    s_barrier
    ds_read_b128 v[180:183], v10 offset:0
    ds_read_b128 v[184:187], v10 offset:2048
    ds_read_b64_tr_b16 v[100:101], v12 offset:0
    ds_read_b64_tr_b16 v[102:103], v12 offset:1280
    ds_read_b64_tr_b16 v[104:105], v13 offset:32
    ds_read_b64_tr_b16 v[106:107], v13 offset:1312
    ds_read_b64_tr_b16 v[108:109], v12 offset:64
    ds_read_b64_tr_b16 v[110:111], v12 offset:1344
    ds_read_b64_tr_b16 v[112:113], v13 offset:96
    ds_read_b64_tr_b16 v[114:115], v13 offset:1376
    ds_read_b64_tr_b16 v[116:117], v12 offset:128
    ds_read_b64_tr_b16 v[118:119], v12 offset:1408
    ds_read_b64_tr_b16 v[120:121], v13 offset:160
    ds_read_b64_tr_b16 v[122:123], v13 offset:1440
    ds_read_b64_tr_b16 v[124:125], v12 offset:192
    ds_read_b64_tr_b16 v[126:127], v12 offset:1472
    ds_read_b64_tr_b16 v[128:129], v13 offset:224
    ds_read_b64_tr_b16 v[130:131], v13 offset:1504
    ds_read_b64_tr_b16 v[132:133], v12 offset:256
    ds_read_b64_tr_b16 v[134:135], v12 offset:1536
    ds_read_b64_tr_b16 v[136:137], v13 offset:288
    ds_read_b64_tr_b16 v[138:139], v13 offset:1568
A_ML:
    s_waitcnt lgkmcnt(15)
    v_mfma_f32_16x16x32_bf16 v[20:23], v[100:103], v[180:183], v[20:23]
    ds_read_b128 v[188:191], v11 offset:0
    ds_read_b128 v[192:195], v11 offset:2048
    v_mfma_f32_16x16x32_bf16 v[24:27], v[100:103], v[184:187], v[24:27]
    ds_read_b64_tr_b16 v[140:141], v12 offset:10240
    v_mfma_f32_16x16x32_bf16 v[28:31], v[104:107], v[180:183], v[28:31]
    ds_read_b64_tr_b16 v[142:143], v12 offset:11520
    ds_read_b64_tr_b16 v[144:145], v13 offset:10272
    v_mfma_f32_16x16x32_bf16 v[32:35], v[104:107], v[184:187], v[32:35]
    ds_read_b64_tr_b16 v[146:147], v13 offset:11552
    s_waitcnt lgkmcnt(15)
    v_mfma_f32_16x16x32_bf16 v[36:39], v[108:111], v[180:183], v[36:39]
    ds_read_b64_tr_b16 v[148:149], v12 offset:10304
    ds_read_b64_tr_b16 v[150:151], v12 offset:11584
    v_mfma_f32_16x16x32_bf16 v[40:43], v[108:111], v[184:187], v[40:43]
    ds_read_b64_tr_b16 v[152:153], v13 offset:10336
    v_mfma_f32_16x16x32_bf16 v[44:47], v[112:115], v[180:183], v[44:47]
    ds_read_b64_tr_b16 v[154:155], v13 offset:11616
    ds_read_b64_tr_b16 v[156:157], v12 offset:10368
    v_mfma_f32_16x16x32_bf16 v[48:51], v[112:115], v[184:187], v[48:51]
    ds_read_b64_tr_b16 v[158:159], v12 offset:11648
    v_mfma_f32_16x16x32_bf16 v[52:55], v[116:119], v[180:183], v[52:55]
    ds_read_b64_tr_b16 v[160:161], v13 offset:10400
    ds_read_b64_tr_b16 v[162:163], v13 offset:11680
    v_mfma_f32_16x16x32_bf16 v[56:59], v[116:119], v[184:187], v[56:59]
    ds_read_b64_tr_b16 v[164:165], v12 offset:10432
    s_waitcnt lgkmcnt(15)
    v_mfma_f32_16x16x32_bf16 v[60:63], v[120:123], v[180:183], v[60:63]
    ds_read_b64_tr_b16 v[166:167], v12 offset:11712
    ds_read_b64_tr_b16 v[168:169], v13 offset:10464
    v_mfma_f32_16x16x32_bf16 v[64:67], v[120:123], v[184:187], v[64:67]
    ds_read_b64_tr_b16 v[170:171], v13 offset:11744
    v_mfma_f32_16x16x32_bf16 v[68:71], v[124:127], v[180:183], v[68:71]
    ds_read_b64_tr_b16 v[172:173], v12 offset:10496
    ds_read_b64_tr_b16 v[174:175], v12 offset:11776
    v_mfma_f32_16x16x32_bf16 v[72:75], v[124:127], v[184:187], v[72:75]
    ds_read_b64_tr_b16 v[176:177], v13 offset:10528
    v_mfma_f32_16x16x32_bf16 v[76:79], v[128:131], v[180:183], v[76:79]
    ds_read_b64_tr_b16 v[178:179], v13 offset:11808
    v_mfma_f32_16x16x32_bf16 v[80:83], v[128:131], v[184:187], v[80:83]
    s_add_u32 s50, s50, 36864
    s_cmp_eq_u32 s50, 110592
    v_mfma_f32_16x16x32_bf16 v[84:87], v[132:135], v[180:183], v[84:87]
    s_cselect_b32 s50, 0, s50
    s_sub_u32 s54, s54, 1
    v_mfma_f32_16x16x32_bf16 v[88:91], v[132:135], v[184:187], v[88:91]
    v_add_u32 v10, s50, v14
    v_add_u32 v13, s50, v15
    v_mfma_f32_16x16x32_bf16 v[92:95], v[136:139], v[180:183], v[92:95]
    v_add_u32 v12, v13, v16
    v_sub_u32 v13, v13, v16
    v_mfma_f32_16x16x32_bf16 v[96:99], v[136:139], v[184:187], v[96:99]
    v_xor_b32 v11, 64, v10
    s_waitcnt lgkmcnt(0)
    s_barrier
    v_mfma_f32_16x16x32_bf16 v[20:23], v[140:143], v[188:191], v[20:23]
    ds_read_b128 v[180:183], v10 offset:0
    ds_read_b128 v[184:187], v10 offset:2048
    v_mfma_f32_16x16x32_bf16 v[24:27], v[140:143], v[192:195], v[24:27]
    ds_read_b64_tr_b16 v[100:101], v12 offset:0
    v_mfma_f32_16x16x32_bf16 v[28:31], v[144:147], v[188:191], v[28:31]
    ds_read_b64_tr_b16 v[102:103], v12 offset:1280
    ds_read_b64_tr_b16 v[104:105], v13 offset:32
    v_mfma_f32_16x16x32_bf16 v[32:35], v[144:147], v[192:195], v[32:35]
    ds_read_b64_tr_b16 v[106:107], v13 offset:1312
    v_mfma_f32_16x16x32_bf16 v[36:39], v[148:151], v[188:191], v[36:39]
    ds_read_b64_tr_b16 v[108:109], v12 offset:64
    ds_read_b64_tr_b16 v[110:111], v12 offset:1344
    v_mfma_f32_16x16x32_bf16 v[40:43], v[148:151], v[192:195], v[40:43]
    ds_read_b64_tr_b16 v[112:113], v13 offset:96
    v_mfma_f32_16x16x32_bf16 v[44:47], v[152:155], v[188:191], v[44:47]
    ds_read_b64_tr_b16 v[114:115], v13 offset:1376
    ds_read_b64_tr_b16 v[116:117], v12 offset:128
    v_mfma_f32_16x16x32_bf16 v[48:51], v[152:155], v[192:195], v[48:51]
    ds_read_b64_tr_b16 v[118:119], v12 offset:1408
    v_mfma_f32_16x16x32_bf16 v[52:55], v[156:159], v[188:191], v[52:55]
    ds_read_b64_tr_b16 v[120:121], v13 offset:160
    v_mfma_f32_16x16x32_bf16 v[56:59], v[156:159], v[192:195], v[56:59]
    ds_read_b64_tr_b16 v[122:123], v13 offset:1440
    ds_read_b64_tr_b16 v[124:125], v12 offset:192
    v_mfma_f32_16x16x32_bf16 v[60:63], v[160:163], v[188:191], v[60:63]
    ds_read_b64_tr_b16 v[126:127], v12 offset:1472
    v_mfma_f32_16x16x32_bf16 v[64:67], v[160:163], v[192:195], v[64:67]
    ds_read_b64_tr_b16 v[128:129], v13 offset:224
    ds_read_b64_tr_b16 v[130:131], v13 offset:1504
    v_mfma_f32_16x16x32_bf16 v[68:71], v[164:167], v[188:191], v[68:71]
    ds_read_b64_tr_b16 v[132:133], v12 offset:256
    v_mfma_f32_16x16x32_bf16 v[72:75], v[164:167], v[192:195], v[72:75]
    ds_read_b64_tr_b16 v[134:135], v12 offset:1536
    ds_read_b64_tr_b16 v[136:137], v13 offset:288
    v_mfma_f32_16x16x32_bf16 v[76:79], v[168:171], v[188:191], v[76:79]
    ds_read_b64_tr_b16 v[138:139], v13 offset:1568
    v_mfma_f32_16x16x32_bf16 v[80:83], v[168:171], v[192:195], v[80:83]
    s_cmp_lg_u32 s54, 0
    v_mfma_f32_16x16x32_bf16 v[84:87], v[172:175], v[188:191], v[84:87]
    v_mfma_f32_16x16x32_bf16 v[88:91], v[172:175], v[192:195], v[88:91]
    v_mfma_f32_16x16x32_bf16 v[92:95], v[176:179], v[188:191], v[92:95]
    v_mfma_f32_16x16x32_bf16 v[96:99], v[176:179], v[192:195], v[96:99]
    s_cbranch_scc1 A_ML
A_MLE:
    s_waitcnt vmcnt(0)
    ds_read_b128 v[236:239], v9 offset:0
    ds_read_b128 v[240:243], v9 offset:256
    ds_read_b64 v[196:197], v18 offset:0
    ds_read_b64 v[200:201], v18 offset:128
    ds_read_b64 v[204:205], v18 offset:256
    ds_read_b64 v[208:209], v18 offset:384
    ds_read_b64 v[212:213], v18 offset:512
    ds_read_b64 v[216:217], v18 offset:640
    ds_read_b64 v[220:221], v18 offset:768
    ds_read_b64 v[224:225], v18 offset:896
    ds_read_b64 v[228:229], v18 offset:1024
    ds_read_b64 v[232:233], v18 offset:1152
    v_mov_b32 v12, 0
    v_mov_b32 v13, 0
    s_waitcnt lgkmcnt(11)
    v_lshrrev_b32 v5, 16, v239
    v_cndmask_b32 v4, 0, v236, s[64:65]
    v_cndmask_b32 v5, 0, v5, s[64:65]
    s_waitcnt lgkmcnt(10)
    v_lshrrev_b32 v11, 16, v243
    v_cndmask_b32 v10, 0, v240, s[64:65]
    v_cndmask_b32 v11, 0, v11, s[64:65]
    s_waitcnt lgkmcnt(9)
    v_mfma_f32_16x16x32_bf16 v[20:23], v[196:199], v[4:7], v[20:23]
    v_mov_b32 v244, v237
    v_mfma_f32_16x16x32_bf16 v[24:27], v[196:199], v[10:13], v[24:27]
    v_mov_b32 v245, v237
    s_waitcnt lgkmcnt(8)
    v_mfma_f32_16x16x32_bf16 v[28:31], v[200:203], v[4:7], v[28:31]
    v_mov_b32 v248, v238
    v_mfma_f32_16x16x32_bf16 v[32:35], v[200:203], v[10:13], v[32:35]
    v_mov_b32 v249, v238
    s_waitcnt lgkmcnt(7)
    v_mfma_f32_16x16x32_bf16 v[36:39], v[204:207], v[4:7], v[36:39]
    v_mov_b32 v252, v239
    v_mfma_f32_16x16x32_bf16 v[40:43], v[204:207], v[10:13], v[40:43]
    v_mov_b32 v253, v239
    s_waitcnt lgkmcnt(6)
    v_mfma_f32_16x16x32_bf16 v[44:47], v[208:211], v[4:7], v[44:47]
    v_mov_b32 v246, v241
    v_mfma_f32_16x16x32_bf16 v[48:51], v[208:211], v[10:13], v[48:51]
    v_mov_b32 v247, v241
    s_waitcnt lgkmcnt(5)
    v_mfma_f32_16x16x32_bf16 v[52:55], v[212:215], v[4:7], v[52:55]
    v_mov_b32 v250, v242
    v_mfma_f32_16x16x32_bf16 v[56:59], v[212:215], v[10:13], v[56:59]
    v_mov_b32 v251, v242
    s_waitcnt lgkmcnt(4)
    v_mfma_f32_16x16x32_bf16 v[60:63], v[216:219], v[4:7], v[60:63]
    v_mov_b32 v254, v243
    v_mfma_f32_16x16x32_bf16 v[64:67], v[216:219], v[10:13], v[64:67]
    v_mov_b32 v255, v243
    s_waitcnt lgkmcnt(3)
    v_mfma_f32_16x16x32_bf16 v[68:71], v[220:223], v[4:7], v[68:71]
    v_mfma_f32_16x16x32_bf16 v[72:75], v[220:223], v[10:13], v[72:75]
    s_waitcnt lgkmcnt(2)
    v_mfma_f32_16x16x32_bf16 v[76:79], v[224:227], v[4:7], v[76:79]
    v_mfma_f32_16x16x32_bf16 v[80:83], v[224:227], v[10:13], v[80:83]
    s_waitcnt lgkmcnt(1)
    v_mfma_f32_16x16x32_bf16 v[84:87], v[228:231], v[4:7], v[84:87]
    v_mfma_f32_16x16x32_bf16 v[88:91], v[228:231], v[10:13], v[88:91]
    s_waitcnt lgkmcnt(0)
    v_mfma_f32_16x16x32_bf16 v[92:95], v[232:235], v[4:7], v[92:95]
    v_mfma_f32_16x16x32_bf16 v[96:99], v[232:235], v[10:13], v[96:99]
    v_pk_mul_f32 v[100:101], v[20:21], v[20:21]
    v_pk_mul_f32 v[102:103], v[22:23], v[22:23]
    v_pk_mul_f32 v[104:105], v[28:29], v[28:29]
    v_pk_mul_f32 v[106:107], v[30:31], v[30:31]
    v_pk_fma_f32 v[100:101], v[100:101], v[244:245], v[248:249]
    v_pk_fma_f32 v[102:103], v[102:103], v[244:245], v[248:249]
    v_pk_fma_f32 v[104:105], v[104:105], v[244:245], v[248:249]
    v_pk_fma_f32 v[106:107], v[106:107], v[244:245], v[248:249]
    v_pk_mul_f32 v[100:101], v[100:101], v[20:21]
    v_pk_mul_f32 v[102:103], v[102:103], v[22:23]
    v_pk_mul_f32 v[104:105], v[104:105], v[28:29]
    v_pk_mul_f32 v[106:107], v[106:107], v[30:31]
    v_exp_f32 v100, v100
    v_exp_f32 v101, v101
    v_exp_f32 v102, v102
    v_exp_f32 v103, v103
    v_exp_f32 v104, v104
    v_exp_f32 v105, v105
    v_exp_f32 v106, v106
    v_exp_f32 v107, v107
    v_pk_fma_f32 v[100:101], v[100:101], v[252:253], v[252:253]
    v_pk_fma_f32 v[102:103], v[102:103], v[252:253], v[252:253]
    v_pk_fma_f32 v[104:105], v[104:105], v[252:253], v[252:253]
    v_pk_fma_f32 v[106:107], v[106:107], v[252:253], v[252:253]
    v_rcp_f32 v100, v100
    v_pk_mul_f32 v[108:109], v[24:25], v[24:25]
    v_pk_mul_f32 v[110:111], v[26:27], v[26:27]
    v_rcp_f32 v101, v101
    v_pk_mul_f32 v[112:113], v[32:33], v[32:33]
    v_rcp_f32 v102, v102
    v_pk_mul_f32 v[114:115], v[34:35], v[34:35]
    v_pk_fma_f32 v[108:109], v[108:109], v[246:247], v[250:251]
    v_rcp_f32 v103, v103
    v_pk_fma_f32 v[110:111], v[110:111], v[246:247], v[250:251]
    v_rcp_f32 v104, v104
    v_pk_fma_f32 v[112:113], v[112:113], v[246:247], v[250:251]
    v_pk_fma_f32 v[114:115], v[114:115], v[246:247], v[250:251]
    v_rcp_f32 v105, v105
    v_pk_mul_f32 v[108:109], v[108:109], v[24:25]
    v_rcp_f32 v106, v106
    v_pk_mul_f32 v[110:111], v[110:111], v[26:27]
    v_pk_mul_f32 v[112:113], v[112:113], v[32:33]
    v_rcp_f32 v107, v107
    v_pk_mul_f32 v[114:115], v[114:115], v[34:35]
    v_exp_f32 v108, v108
    v_pk_mul_f32 v[100:101], v[100:101], v[20:21]
    v_pk_mul_f32 v[102:103], v[102:103], v[22:23]
    v_exp_f32 v109, v109
    v_pk_mul_f32 v[104:105], v[104:105], v[28:29]
    v_exp_f32 v110, v110
    v_pk_mul_f32 v[106:107], v[106:107], v[30:31]
    v_exp_f32 v111, v111
    v_cvt_pk_bf16_f32 v124, v100, v101
    v_exp_f32 v112, v112
    v_cvt_pk_bf16_f32 v125, v102, v103
    v_exp_f32 v113, v113
    v_cvt_pk_bf16_f32 v126, v104, v105
    v_exp_f32 v114, v114
    v_cvt_pk_bf16_f32 v127, v106, v107
    v_exp_f32 v115, v115
    buffer_store_dwordx4 v[124:127], v3, s[20:23], s58 offen offset:0 sc1
    v_pk_fma_f32 v[108:109], v[108:109], v[254:255], v[254:255]
    v_pk_fma_f32 v[110:111], v[110:111], v[254:255], v[254:255]
    v_pk_fma_f32 v[112:113], v[112:113], v[254:255], v[254:255]
    v_pk_fma_f32 v[114:115], v[114:115], v[254:255], v[254:255]
    v_rcp_f32 v108, v108
    v_pk_mul_f32 v[116:117], v[36:37], v[36:37]
    v_pk_mul_f32 v[118:119], v[38:39], v[38:39]
    v_rcp_f32 v109, v109
    v_pk_mul_f32 v[120:121], v[44:45], v[44:45]
    v_rcp_f32 v110, v110
    v_pk_mul_f32 v[122:123], v[46:47], v[46:47]
    v_pk_fma_f32 v[116:117], v[116:117], v[244:245], v[248:249]
    v_rcp_f32 v111, v111
    v_pk_fma_f32 v[118:119], v[118:119], v[244:245], v[248:249]
    v_rcp_f32 v112, v112
    v_pk_fma_f32 v[120:121], v[120:121], v[244:245], v[248:249]
    v_pk_fma_f32 v[122:123], v[122:123], v[244:245], v[248:249]
    v_rcp_f32 v113, v113
    v_pk_mul_f32 v[116:117], v[116:117], v[36:37]
    v_rcp_f32 v114, v114
    v_pk_mul_f32 v[118:119], v[118:119], v[38:39]
    v_pk_mul_f32 v[120:121], v[120:121], v[44:45]
    v_rcp_f32 v115, v115
    v_pk_mul_f32 v[122:123], v[122:123], v[46:47]
    v_exp_f32 v116, v116
    v_pk_mul_f32 v[108:109], v[108:109], v[24:25]
    v_pk_mul_f32 v[110:111], v[110:111], v[26:27]
    v_exp_f32 v117, v117
    v_pk_mul_f32 v[112:113], v[112:113], v[32:33]
    v_exp_f32 v118, v118
    v_pk_mul_f32 v[114:115], v[114:115], v[34:35]
    v_exp_f32 v119, v119
    v_cvt_pk_bf16_f32 v128, v108, v109
    v_exp_f32 v120, v120
    v_cvt_pk_bf16_f32 v129, v110, v111
    v_exp_f32 v121, v121
    v_cvt_pk_bf16_f32 v130, v112, v113
    v_exp_f32 v122, v122
    v_cvt_pk_bf16_f32 v131, v114, v115
    v_exp_f32 v123, v123
    buffer_store_dwordx4 v[128:131], v3, s[20:23], s58 offen offset:1024 sc1
    s_add_u32 s57, s57, 4096
    v_pk_fma_f32 v[116:117], v[116:117], v[252:253], v[252:253]
    v_pk_fma_f32 v[118:119], v[118:119], v[252:253], v[252:253]
    v_pk_fma_f32 v[120:121], v[120:121], v[252:253], v[252:253]
    v_pk_fma_f32 v[122:123], v[122:123], v[252:253], v[252:253]
    v_rcp_f32 v116, v116
    v_pk_mul_f32 v[100:101], v[40:41], v[40:41]
    v_pk_mul_f32 v[102:103], v[42:43], v[42:43]
    v_rcp_f32 v117, v117
    v_pk_mul_f32 v[104:105], v[48:49], v[48:49]
    v_rcp_f32 v118, v118
    v_pk_mul_f32 v[106:107], v[50:51], v[50:51]
    v_pk_fma_f32 v[100:101], v[100:101], v[246:247], v[250:251]
    v_rcp_f32 v119, v119
    v_pk_fma_f32 v[102:103], v[102:103], v[246:247], v[250:251]
    v_rcp_f32 v120, v120
    v_pk_fma_f32 v[104:105], v[104:105], v[246:247], v[250:251]
    v_pk_fma_f32 v[106:107], v[106:107], v[246:247], v[250:251]
    v_rcp_f32 v121, v121
    v_pk_mul_f32 v[100:101], v[100:101], v[40:41]
    v_rcp_f32 v122, v122
    v_pk_mul_f32 v[102:103], v[102:103], v[42:43]
    v_pk_mul_f32 v[104:105], v[104:105], v[48:49]
    v_rcp_f32 v123, v123
    v_pk_mul_f32 v[106:107], v[106:107], v[50:51]
    v_exp_f32 v100, v100
    v_pk_mul_f32 v[116:117], v[116:117], v[36:37]
    v_pk_mul_f32 v[118:119], v[118:119], v[38:39]
    v_exp_f32 v101, v101
    v_pk_mul_f32 v[120:121], v[120:121], v[44:45]
    v_exp_f32 v102, v102
    v_pk_mul_f32 v[122:123], v[122:123], v[46:47]
    v_exp_f32 v103, v103
    v_cvt_pk_bf16_f32 v132, v116, v117
    v_exp_f32 v104, v104
    v_cvt_pk_bf16_f32 v133, v118, v119
    v_exp_f32 v105, v105
    v_cvt_pk_bf16_f32 v134, v120, v121
    v_exp_f32 v106, v106
    v_cvt_pk_bf16_f32 v135, v122, v123
    v_exp_f32 v107, v107
    buffer_store_dwordx4 v[132:135], v3, s[20:23], s57 offen offset:0 sc1
    v_pk_fma_f32 v[100:101], v[100:101], v[254:255], v[254:255]
    v_pk_fma_f32 v[102:103], v[102:103], v[254:255], v[254:255]
    v_pk_fma_f32 v[104:105], v[104:105], v[254:255], v[254:255]
    v_pk_fma_f32 v[106:107], v[106:107], v[254:255], v[254:255]
    v_rcp_f32 v100, v100
    v_pk_mul_f32 v[108:109], v[52:53], v[52:53]
    v_pk_mul_f32 v[110:111], v[54:55], v[54:55]
    v_rcp_f32 v101, v101
    v_pk_mul_f32 v[112:113], v[60:61], v[60:61]
    v_rcp_f32 v102, v102
    v_pk_mul_f32 v[114:115], v[62:63], v[62:63]
    v_pk_fma_f32 v[108:109], v[108:109], v[244:245], v[248:249]
    v_rcp_f32 v103, v103
    v_pk_fma_f32 v[110:111], v[110:111], v[244:245], v[248:249]
    v_rcp_f32 v104, v104
    v_pk_fma_f32 v[112:113], v[112:113], v[244:245], v[248:249]
    v_pk_fma_f32 v[114:115], v[114:115], v[244:245], v[248:249]
    v_rcp_f32 v105, v105
    v_pk_mul_f32 v[108:109], v[108:109], v[52:53]
    v_rcp_f32 v106, v106
    v_pk_mul_f32 v[110:111], v[110:111], v[54:55]
    v_pk_mul_f32 v[112:113], v[112:113], v[60:61]
    v_rcp_f32 v107, v107
    v_pk_mul_f32 v[114:115], v[114:115], v[62:63]
    v_exp_f32 v108, v108
    v_pk_mul_f32 v[100:101], v[100:101], v[40:41]
    v_pk_mul_f32 v[102:103], v[102:103], v[42:43]
    v_exp_f32 v109, v109
    v_pk_mul_f32 v[104:105], v[104:105], v[48:49]
    v_exp_f32 v110, v110
    v_pk_mul_f32 v[106:107], v[106:107], v[50:51]
    v_exp_f32 v111, v111
    v_cvt_pk_bf16_f32 v136, v100, v101
    v_exp_f32 v112, v112
    v_cvt_pk_bf16_f32 v137, v102, v103
    v_exp_f32 v113, v113
    v_cvt_pk_bf16_f32 v138, v104, v105
    v_exp_f32 v114, v114
    v_cvt_pk_bf16_f32 v139, v106, v107
    v_exp_f32 v115, v115
    buffer_store_dwordx4 v[136:139], v3, s[20:23], s57 offen offset:1024 sc1
    s_add_u32 s57, s57, 4096
    v_pk_fma_f32 v[108:109], v[108:109], v[252:253], v[252:253]
    v_pk_fma_f32 v[110:111], v[110:111], v[252:253], v[252:253]
    v_pk_fma_f32 v[112:113], v[112:113], v[252:253], v[252:253]
    v_pk_fma_f32 v[114:115], v[114:115], v[252:253], v[252:253]
    v_rcp_f32 v108, v108
    v_pk_mul_f32 v[116:117], v[56:57], v[56:57]
    v_pk_mul_f32 v[118:119], v[58:59], v[58:59]
    v_rcp_f32 v109, v109
    v_pk_mul_f32 v[120:121], v[64:65], v[64:65]
    v_rcp_f32 v110, v110
    v_pk_mul_f32 v[122:123], v[66:67], v[66:67]
    v_pk_fma_f32 v[116:117], v[116:117], v[246:247], v[250:251]
    v_rcp_f32 v111, v111
    v_pk_fma_f32 v[118:119], v[118:119], v[246:247], v[250:251]
    v_rcp_f32 v112, v112
    v_pk_fma_f32 v[120:121], v[120:121], v[246:247], v[250:251]
    v_pk_fma_f32 v[122:123], v[122:123], v[246:247], v[250:251]
    v_rcp_f32 v113, v113
    v_pk_mul_f32 v[116:117], v[116:117], v[56:57]
    v_rcp_f32 v114, v114
    v_pk_mul_f32 v[118:119], v[118:119], v[58:59]
    v_pk_mul_f32 v[120:121], v[120:121], v[64:65]
    v_rcp_f32 v115, v115
    v_pk_mul_f32 v[122:123], v[122:123], v[66:67]
    v_exp_f32 v116, v116
    v_pk_mul_f32 v[108:109], v[108:109], v[52:53]
    v_pk_mul_f32 v[110:111], v[110:111], v[54:55]
    v_exp_f32 v117, v117
    v_pk_mul_f32 v[112:113], v[112:113], v[60:61]
    v_exp_f32 v118, v118
    v_pk_mul_f32 v[114:115], v[114:115], v[62:63]
    v_exp_f32 v119, v119
    v_cvt_pk_bf16_f32 v124, v108, v109
    v_exp_f32 v120, v120
    v_cvt_pk_bf16_f32 v125, v110, v111
    v_exp_f32 v121, v121
    v_cvt_pk_bf16_f32 v126, v112, v113
    v_exp_f32 v122, v122
    v_cvt_pk_bf16_f32 v127, v114, v115
    v_exp_f32 v123, v123
    buffer_store_dwordx4 v[124:127], v3, s[20:23], s57 offen offset:0 sc1
    v_pk_fma_f32 v[116:117], v[116:117], v[254:255], v[254:255]
    v_pk_fma_f32 v[118:119], v[118:119], v[254:255], v[254:255]
    v_pk_fma_f32 v[120:121], v[120:121], v[254:255], v[254:255]
    v_pk_fma_f32 v[122:123], v[122:123], v[254:255], v[254:255]
    v_rcp_f32 v116, v116
    v_pk_mul_f32 v[100:101], v[68:69], v[68:69]
    v_pk_mul_f32 v[102:103], v[70:71], v[70:71]
    v_rcp_f32 v117, v117
    v_pk_mul_f32 v[104:105], v[76:77], v[76:77]
    v_rcp_f32 v118, v118
    v_pk_mul_f32 v[106:107], v[78:79], v[78:79]
    v_pk_fma_f32 v[100:101], v[100:101], v[244:245], v[248:249]
    v_rcp_f32 v119, v119
    v_pk_fma_f32 v[102:103], v[102:103], v[244:245], v[248:249]
    v_rcp_f32 v120, v120
    v_pk_fma_f32 v[104:105], v[104:105], v[244:245], v[248:249]
    v_pk_fma_f32 v[106:107], v[106:107], v[244:245], v[248:249]
    v_rcp_f32 v121, v121
    v_pk_mul_f32 v[100:101], v[100:101], v[68:69]
    v_rcp_f32 v122, v122
    v_pk_mul_f32 v[102:103], v[102:103], v[70:71]
    v_pk_mul_f32 v[104:105], v[104:105], v[76:77]
    v_rcp_f32 v123, v123
    v_pk_mul_f32 v[106:107], v[106:107], v[78:79]
    v_exp_f32 v100, v100
    v_pk_mul_f32 v[116:117], v[116:117], v[56:57]
    v_pk_mul_f32 v[118:119], v[118:119], v[58:59]
    v_exp_f32 v101, v101
    v_pk_mul_f32 v[120:121], v[120:121], v[64:65]
    v_exp_f32 v102, v102
    v_pk_mul_f32 v[122:123], v[122:123], v[66:67]
    v_exp_f32 v103, v103
    v_cvt_pk_bf16_f32 v128, v116, v117
    v_exp_f32 v104, v104
    v_cvt_pk_bf16_f32 v129, v118, v119
    v_exp_f32 v105, v105
    v_cvt_pk_bf16_f32 v130, v120, v121
    v_exp_f32 v106, v106
    v_cvt_pk_bf16_f32 v131, v122, v123
    v_exp_f32 v107, v107
    buffer_store_dwordx4 v[128:131], v3, s[20:23], s57 offen offset:1024 sc1
    s_add_u32 s57, s57, 4096
    v_pk_fma_f32 v[100:101], v[100:101], v[252:253], v[252:253]
    v_pk_fma_f32 v[102:103], v[102:103], v[252:253], v[252:253]
    v_pk_fma_f32 v[104:105], v[104:105], v[252:253], v[252:253]
    v_pk_fma_f32 v[106:107], v[106:107], v[252:253], v[252:253]
    v_rcp_f32 v100, v100
    v_pk_mul_f32 v[108:109], v[72:73], v[72:73]
    v_pk_mul_f32 v[110:111], v[74:75], v[74:75]
    v_rcp_f32 v101, v101
    v_pk_mul_f32 v[112:113], v[80:81], v[80:81]
    v_rcp_f32 v102, v102
    v_pk_mul_f32 v[114:115], v[82:83], v[82:83]
    v_pk_fma_f32 v[108:109], v[108:109], v[246:247], v[250:251]
    v_rcp_f32 v103, v103
    v_pk_fma_f32 v[110:111], v[110:111], v[246:247], v[250:251]
    v_rcp_f32 v104, v104
    v_pk_fma_f32 v[112:113], v[112:113], v[246:247], v[250:251]
    v_pk_fma_f32 v[114:115], v[114:115], v[246:247], v[250:251]
    v_rcp_f32 v105, v105
    v_pk_mul_f32 v[108:109], v[108:109], v[72:73]
    v_rcp_f32 v106, v106
    v_pk_mul_f32 v[110:111], v[110:111], v[74:75]
    v_pk_mul_f32 v[112:113], v[112:113], v[80:81]
    v_rcp_f32 v107, v107
    v_pk_mul_f32 v[114:115], v[114:115], v[82:83]
    v_exp_f32 v108, v108
    v_pk_mul_f32 v[100:101], v[100:101], v[68:69]
    v_pk_mul_f32 v[102:103], v[102:103], v[70:71]
    v_exp_f32 v109, v109
    v_pk_mul_f32 v[104:105], v[104:105], v[76:77]
    v_exp_f32 v110, v110
    v_pk_mul_f32 v[106:107], v[106:107], v[78:79]
    v_exp_f32 v111, v111
    v_cvt_pk_bf16_f32 v132, v100, v101
    v_exp_f32 v112, v112
    v_cvt_pk_bf16_f32 v133, v102, v103
    v_exp_f32 v113, v113
    v_cvt_pk_bf16_f32 v134, v104, v105
    v_exp_f32 v114, v114
    v_cvt_pk_bf16_f32 v135, v106, v107
    v_exp_f32 v115, v115
    buffer_store_dwordx4 v[132:135], v3, s[20:23], s57 offen offset:0 sc1
    v_pk_fma_f32 v[108:109], v[108:109], v[254:255], v[254:255]
    v_pk_fma_f32 v[110:111], v[110:111], v[254:255], v[254:255]
    v_pk_fma_f32 v[112:113], v[112:113], v[254:255], v[254:255]
    v_pk_fma_f32 v[114:115], v[114:115], v[254:255], v[254:255]
    v_rcp_f32 v108, v108
    v_pk_mul_f32 v[116:117], v[84:85], v[84:85]
    v_pk_mul_f32 v[118:119], v[86:87], v[86:87]
    v_rcp_f32 v109, v109
    v_pk_mul_f32 v[120:121], v[92:93], v[92:93]
    v_rcp_f32 v110, v110
    v_pk_mul_f32 v[122:123], v[94:95], v[94:95]
    v_pk_fma_f32 v[116:117], v[116:117], v[244:245], v[248:249]
    v_rcp_f32 v111, v111
    v_pk_fma_f32 v[118:119], v[118:119], v[244:245], v[248:249]
    v_rcp_f32 v112, v112
    v_pk_fma_f32 v[120:121], v[120:121], v[244:245], v[248:249]
    v_pk_fma_f32 v[122:123], v[122:123], v[244:245], v[248:249]
    v_rcp_f32 v113, v113
    v_pk_mul_f32 v[116:117], v[116:117], v[84:85]
    v_rcp_f32 v114, v114
    v_pk_mul_f32 v[118:119], v[118:119], v[86:87]
    v_pk_mul_f32 v[120:121], v[120:121], v[92:93]
    v_rcp_f32 v115, v115
    v_pk_mul_f32 v[122:123], v[122:123], v[94:95]
    v_exp_f32 v116, v116
    v_pk_mul_f32 v[108:109], v[108:109], v[72:73]
    v_pk_mul_f32 v[110:111], v[110:111], v[74:75]
    v_exp_f32 v117, v117
    v_pk_mul_f32 v[112:113], v[112:113], v[80:81]
    v_exp_f32 v118, v118
    v_pk_mul_f32 v[114:115], v[114:115], v[82:83]
    v_exp_f32 v119, v119
    v_cvt_pk_bf16_f32 v136, v108, v109
    v_exp_f32 v120, v120
    v_cvt_pk_bf16_f32 v137, v110, v111
    v_exp_f32 v121, v121
    v_cvt_pk_bf16_f32 v138, v112, v113
    v_exp_f32 v122, v122
    v_cvt_pk_bf16_f32 v139, v114, v115
    v_exp_f32 v123, v123
    buffer_store_dwordx4 v[136:139], v3, s[20:23], s57 offen offset:1024 sc1
    s_add_u32 s57, s57, 4096
    v_pk_fma_f32 v[116:117], v[116:117], v[252:253], v[252:253]
    v_pk_fma_f32 v[118:119], v[118:119], v[252:253], v[252:253]
    v_pk_fma_f32 v[120:121], v[120:121], v[252:253], v[252:253]
    v_pk_fma_f32 v[122:123], v[122:123], v[252:253], v[252:253]
    v_rcp_f32 v116, v116
    v_pk_mul_f32 v[100:101], v[88:89], v[88:89]
    v_pk_mul_f32 v[102:103], v[90:91], v[90:91]
    v_rcp_f32 v117, v117
    v_pk_mul_f32 v[104:105], v[96:97], v[96:97]
    v_rcp_f32 v118, v118
    v_pk_mul_f32 v[106:107], v[98:99], v[98:99]
    v_pk_fma_f32 v[100:101], v[100:101], v[246:247], v[250:251]
    v_rcp_f32 v119, v119
    v_pk_fma_f32 v[102:103], v[102:103], v[246:247], v[250:251]
    v_rcp_f32 v120, v120
    v_pk_fma_f32 v[104:105], v[104:105], v[246:247], v[250:251]
    v_pk_fma_f32 v[106:107], v[106:107], v[246:247], v[250:251]
    v_rcp_f32 v121, v121
    v_pk_mul_f32 v[100:101], v[100:101], v[88:89]
    v_rcp_f32 v122, v122
    v_pk_mul_f32 v[102:103], v[102:103], v[90:91]
    v_pk_mul_f32 v[104:105], v[104:105], v[96:97]
    v_rcp_f32 v123, v123
    v_pk_mul_f32 v[106:107], v[106:107], v[98:99]
    v_exp_f32 v100, v100
    v_pk_mul_f32 v[116:117], v[116:117], v[84:85]
    v_pk_mul_f32 v[118:119], v[118:119], v[86:87]
    v_exp_f32 v101, v101
    v_pk_mul_f32 v[120:121], v[120:121], v[92:93]
    v_exp_f32 v102, v102
    v_pk_mul_f32 v[122:123], v[122:123], v[94:95]
    v_exp_f32 v103, v103
    v_cvt_pk_bf16_f32 v124, v116, v117
    v_exp_f32 v104, v104
    v_cvt_pk_bf16_f32 v125, v118, v119
    v_exp_f32 v105, v105
    v_cvt_pk_bf16_f32 v126, v120, v121
    v_exp_f32 v106, v106
    v_cvt_pk_bf16_f32 v127, v122, v123
    v_exp_f32 v107, v107
    buffer_store_dwordx4 v[124:127], v3, s[20:23], s57 offen offset:0 sc1
    v_pk_fma_f32 v[100:101], v[100:101], v[254:255], v[254:255]
    v_pk_fma_f32 v[102:103], v[102:103], v[254:255], v[254:255]
    v_pk_fma_f32 v[104:105], v[104:105], v[254:255], v[254:255]
    v_pk_fma_f32 v[106:107], v[106:107], v[254:255], v[254:255]
    v_rcp_f32 v100, v100
    v_rcp_f32 v101, v101
    v_rcp_f32 v102, v102
    v_rcp_f32 v103, v103
    v_rcp_f32 v104, v104
    v_rcp_f32 v105, v105
    v_rcp_f32 v106, v106
    v_rcp_f32 v107, v107
    v_pk_mul_f32 v[100:101], v[100:101], v[88:89]
    v_pk_mul_f32 v[102:103], v[102:103], v[90:91]
    v_pk_mul_f32 v[104:105], v[104:105], v[96:97]
    v_pk_mul_f32 v[106:107], v[106:107], v[98:99]
    v_cvt_pk_bf16_f32 v128, v100, v101
    v_cvt_pk_bf16_f32 v129, v102, v103
    v_cvt_pk_bf16_f32 v130, v104, v105
    v_cvt_pk_bf16_f32 v131, v106, v107
    buffer_store_dwordx4 v[128:131], v3, s[20:23], s57 offen offset:1024 sc1
    s_add_u32 s57, s57, 4096
    v_mov_b32 v4, 159744
    v_mov_b32 v5, 1
    s_waitcnt lgkmcnt(0)
    s_mov_b64 exec, 1
    ds_add_u32 v4, v5
    s_mov_b64 exec, -1
    s_branch B_COMPUTE
A_DFT:
    s_add_u32 s28, s14, 12582912
    s_addc_u32 s29, s15, 0
    s_mov_b32 s30, 2621440
    s_mov_b32 s31, 0x20000
    s_add_u32 s56, s14, 20971520
    s_addc_u32 s57, s15, 0
    s_mov_b32 s58, 28672
    s_mov_b32 s59, 0x20000
    s_lshl_b32 s39, s34, 2
    s_add_u32 s39, s39, s32
    s_lshl_b32 s64, s39, 8
    s_bitcmp1_b32 s39, 0
    s_cselect_b32 s46, 1.0, -1.0
    v_mov_b32 v252, s46
    v_mov_b32 v253, s46
    s_lshr_b32 s46, s39, 1
    s_lshl_b32 s46, s46, 5
    s_and_b32 s52, s39, 1
    s_add_u32 s46, s46, s52
    s_add_u32 s46, s46, 1
    v_lshl_add_u32 v5, v1, 1, s46
    v_mul_u32_u24 v6, s35, v5
    v_mul_u32_u24 v7, 6554, v6
    v_lshrrev_b32 v7, 16, v7
    v_mul_u32_u24 v7, 10, v7
    v_sub_u32 v6, v6, v7
    v_cvt_f32_u32 v6, v6
    v_mul_f32 v6, 0xbdcccccd, v6
    v_cvt_f32_u32 v5, v5
    v_mul_f32 v5, 0xbacccccd, v5
    v_lshlrev_b32 v7, 3, v2
    v_cvt_f32_u32 v7, v7
    v_add_f32 v7, 0.5, v7
    v_fma_f32 v204, v5, v7, v6
    v_mul_f32 v7, 0x42000000, v5
    v_cos_f32 v4, v7
    v_add_f32 v205, v5, v204
    v_add_f32 v206, v5, v205
    v_add_f32 v207, v5, v206
    v_add_f32 v208, v5, v207
    v_add_f32 v209, v5, v208
    v_add_f32 v210, v5, v209
    v_add_f32 v211, v5, v210
    v_sub_f32 v220, v204, v7
    v_sub_f32 v221, v205, v7
    v_sub_f32 v222, v206, v7
    v_sub_f32 v223, v207, v7
    v_sub_f32 v224, v208, v7
    v_sub_f32 v225, v209, v7
    v_sub_f32 v226, v210, v7
    v_sub_f32 v227, v211, v7
    v_add_f32 v4, v4, v4
    v_sin_f32 v212, v204
    v_cos_f32 v204, v204
    v_sin_f32 v213, v205
    v_cos_f32 v205, v205
    v_sin_f32 v214, v206
    v_cos_f32 v206, v206
    v_sin_f32 v215, v207
    v_cos_f32 v207, v207
    v_sin_f32 v216, v208
    v_cos_f32 v208, v208
    v_sin_f32 v217, v209
    v_cos_f32 v209, v209
    v_sin_f32 v218, v210
    v_cos_f32 v210, v210
    v_sin_f32 v219, v211
    v_cos_f32 v211, v211
    v_sin_f32 v228, v220
    v_cos_f32 v220, v220
    v_sin_f32 v229, v221
    v_cos_f32 v221, v221
    v_sin_f32 v230, v222
    v_cos_f32 v222, v222
    v_sin_f32 v231, v223
    v_cos_f32 v223, v223
    v_sin_f32 v232, v224
    v_cos_f32 v224, v224
    v_sin_f32 v233, v225
    v_cos_f32 v225, v225
    v_sin_f32 v234, v226
    v_cos_f32 v226, v226
    v_sin_f32 v235, v227
    v_cos_f32 v227, v227
    v_cvt_pk_bf16_f32 v188, v204, v205
    v_cvt_pk_bf16_f32 v189, v206, v207
    v_cvt_pk_bf16_f32 v190, v208, v209
    v_cvt_pk_bf16_f32 v191, v210, v211
    v_cvt_pk_bf16_f32 v192, v212, v213
    v_cvt_pk_bf16_f32 v193, v214, v215
    v_cvt_pk_bf16_f32 v194, v216, v217
    v_cvt_pk_bf16_f32 v195, v218, v219
    v_mov_b32 v196, 0
    v_mov_b32 v197, 0
    v_mov_b32 v198, 0
    v_mov_b32 v199, 0
    s_nop 1
    v_mfma_f32_32x32x16_bf16 v[28:43], v[196:199], v[196:199], 0
    v_mfma_f32_32x32x16_bf16 v[44:59], v[196:199], v[196:199], 0
    v_mfma_f32_32x32x16_bf16 v[60:75], v[196:199], v[196:199], 0
    v_mfma_f32_32x32x16_bf16 v[76:91], v[196:199], v[196:199], 0
    v_mfma_f32_32x32x16_bf16 v[92:107], v[196:199], v[196:199], 0
    v_mfma_f32_32x32x16_bf16 v[108:123], v[196:199], v[196:199], 0
    v_mfma_f32_32x32x16_bf16 v[124:139], v[196:199], v[196:199], 0
    v_mfma_f32_32x32x16_bf16 v[140:155], v[196:199], v[196:199], 0
    s_mov_b32 s54, 5
    v_add_u32 v10, s50, v8
    v_xor_b32 v11, 64, v10
    v_add_u32 v13, 98304, v3
    s_lshl_b32 s46, s32, 13
    v_and_b32 v5, 7, v1
    v_xor_b32 v5, v5, v2
    v_lshlrev_b32 v5, 4, v5
    v_lshl_add_u32 v5, v1, 8, v5
    v_add_u32 v14, s46, v5
    v_xor_b32 v15, 64, v14
    v_xor_b32 v18, v1, v2
    v_lshlrev_b32 v18, 4, v18
    v_lshl_add_u32 v18, v2, 8, v18
    v_add_u32 v18, s46, v18
    v_xor_b32 v19, 64, v18
    v_mul_u32_u24 v20, 81920, v2
    v_lshl_add_u32 v20, v1, 4, v20
    s_lshl_b32 s65, s39, 12
    s_lshl_b32 s52, s33, 8
    s_add_u32 s65, s65, s52
    s_mov_b32 s70, 0x80008000
    v_mov_b32 v16, 159744
    v_mov_b32 v17, 0
    ds_write_b32 v16, v17
    v_mov_b32 v21, 1
    s_waitcnt lgkmcnt(0)
    s_barrier
    ds_read_b128 v[156:159], v10 offset:0
    ds_read_b128 v[160:163], v10 offset:2048
    ds_read_b128 v[164:167], v10 offset:4096
    ds_read_b128 v[168:171], v10 offset:6144
    ds_read_b128 v[172:175], v10 offset:8192
    ds_read_b128 v[176:179], v10 offset:10240
A_DL:
    s_waitcnt lgkmcnt(5)
    v_mfma_f32_16x16x32_bf16 v[28:31], v[156:159], v[188:191], v[28:31]
    ds_read_b128 v[180:183], v10 offset:12288
    v_fma_f32 v220, v4, v204, -v220
    v_mfma_f32_16x16x32_bf16 v[32:35], v[156:159], v[192:195], v[32:35]
    ds_read_b128 v[184:187], v10 offset:14336
    s_waitcnt lgkmcnt(6)
    v_mfma_f32_16x16x32_bf16 v[36:39], v[160:163], v[188:191], v[36:39]
    v_fma_f32 v221, v4, v205, -v221
    v_fma_f32 v222, v4, v206, -v222
    v_mfma_f32_16x16x32_bf16 v[40:43], v[160:163], v[192:195], v[40:43]
    v_fma_f32 v223, v4, v207, -v223
    s_waitcnt lgkmcnt(5)
    v_mfma_f32_16x16x32_bf16 v[44:47], v[164:167], v[188:191], v[44:47]
    ds_read_b128 v[156:159], v10 offset:16384
    v_fma_f32 v224, v4, v208, -v224
    v_mfma_f32_16x16x32_bf16 v[48:51], v[164:167], v[192:195], v[48:51]
    ds_read_b128 v[160:163], v10 offset:18432
    s_waitcnt lgkmcnt(6)
    v_mfma_f32_16x16x32_bf16 v[52:55], v[168:171], v[188:191], v[52:55]
    v_fma_f32 v225, v4, v209, -v225
    v_fma_f32 v226, v4, v210, -v226
    v_mfma_f32_16x16x32_bf16 v[56:59], v[168:171], v[192:195], v[56:59]
    v_fma_f32 v227, v4, v211, -v227
    s_waitcnt lgkmcnt(5)
    v_mfma_f32_16x16x32_bf16 v[60:63], v[172:175], v[188:191], v[60:63]
    ds_read_b128 v[164:167], v10 offset:20480
    v_fma_f32 v228, v4, v212, -v228
    v_mfma_f32_16x16x32_bf16 v[64:67], v[172:175], v[192:195], v[64:67]
    ds_read_b128 v[168:171], v10 offset:22528
    s_waitcnt lgkmcnt(6)
    v_mfma_f32_16x16x32_bf16 v[68:71], v[176:179], v[188:191], v[68:71]
    v_fma_f32 v229, v4, v213, -v229
    v_fma_f32 v230, v4, v214, -v230
    v_mfma_f32_16x16x32_bf16 v[72:75], v[176:179], v[192:195], v[72:75]
    v_fma_f32 v231, v4, v215, -v231
    s_waitcnt lgkmcnt(5)
    v_mfma_f32_16x16x32_bf16 v[76:79], v[180:183], v[188:191], v[76:79]
    ds_read_b128 v[172:175], v10 offset:24576
    v_fma_f32 v232, v4, v216, -v232
    v_mfma_f32_16x16x32_bf16 v[80:83], v[180:183], v[192:195], v[80:83]
    ds_read_b128 v[176:179], v10 offset:26624
    s_waitcnt lgkmcnt(6)
    v_mfma_f32_16x16x32_bf16 v[84:87], v[184:187], v[188:191], v[84:87]
    v_fma_f32 v233, v4, v217, -v233
    v_fma_f32 v234, v4, v218, -v234
    v_mfma_f32_16x16x32_bf16 v[88:91], v[184:187], v[192:195], v[88:91]
    v_fma_f32 v235, v4, v219, -v235
    s_waitcnt lgkmcnt(5)
    v_mfma_f32_16x16x32_bf16 v[92:95], v[156:159], v[188:191], v[92:95]
    ds_read_b128 v[180:183], v10 offset:28672
    v_cvt_pk_bf16_f32 v196, v220, v221
    v_mfma_f32_16x16x32_bf16 v[96:99], v[156:159], v[192:195], v[96:99]
    ds_read_b128 v[184:187], v10 offset:30720
    s_waitcnt lgkmcnt(6)
    v_mfma_f32_16x16x32_bf16 v[100:103], v[160:163], v[188:191], v[100:103]
    v_cvt_pk_bf16_f32 v197, v222, v223
    v_cvt_pk_bf16_f32 v198, v224, v225
    v_mfma_f32_16x16x32_bf16 v[104:107], v[160:163], v[192:195], v[104:107]
    v_cvt_pk_bf16_f32 v199, v226, v227
    s_waitcnt lgkmcnt(5)
    v_mfma_f32_16x16x32_bf16 v[108:111], v[164:167], v[188:191], v[108:111]
    ds_read_b128 v[156:159], v11 offset:0
    v_cvt_pk_bf16_f32 v200, v228, v229
    v_mfma_f32_16x16x32_bf16 v[112:115], v[164:167], v[192:195], v[112:115]
    ds_read_b128 v[160:163], v11 offset:2048
    s_waitcnt lgkmcnt(6)
    v_mfma_f32_16x16x32_bf16 v[116:119], v[168:171], v[188:191], v[116:119]
    v_cvt_pk_bf16_f32 v201, v230, v231
    v_cvt_pk_bf16_f32 v202, v232, v233
    v_mfma_f32_16x16x32_bf16 v[120:123], v[168:171], v[192:195], v[120:123]
    v_cvt_pk_bf16_f32 v203, v234, v235
    s_waitcnt lgkmcnt(5)
    v_mfma_f32_16x16x32_bf16 v[124:127], v[172:175], v[188:191], v[124:127]
    ds_read_b128 v[164:167], v11 offset:4096
    s_add_u32 s50, s50, 32768
    v_mfma_f32_16x16x32_bf16 v[128:131], v[172:175], v[192:195], v[128:131]
    ds_read_b128 v[168:171], v11 offset:6144
    s_waitcnt lgkmcnt(6)
    v_mfma_f32_16x16x32_bf16 v[132:135], v[176:179], v[188:191], v[132:135]
    s_cmp_eq_u32 s50, 98304
    s_cselect_b32 s50, 0, s50
    v_mfma_f32_16x16x32_bf16 v[136:139], v[176:179], v[192:195], v[136:139]
    s_sub_u32 s54, s54, 1
    s_waitcnt lgkmcnt(5)
    v_mfma_f32_16x16x32_bf16 v[140:143], v[180:183], v[188:191], v[140:143]
    ds_read_b128 v[172:175], v11 offset:8192
    v_mfma_f32_16x16x32_bf16 v[144:147], v[180:183], v[192:195], v[144:147]
    ds_read_b128 v[176:179], v11 offset:10240
    s_waitcnt lgkmcnt(6)
    v_mfma_f32_16x16x32_bf16 v[148:151], v[184:187], v[188:191], v[148:151]
    v_mfma_f32_16x16x32_bf16 v[152:155], v[184:187], v[192:195], v[152:155]
    s_waitcnt lgkmcnt(5)
    v_mfma_f32_16x16x32_bf16 v[28:31], v[156:159], v[196:199], v[28:31]
    ds_read_b128 v[180:183], v11 offset:12288
    v_fma_f32 v204, v4, v220, -v204
    v_mfma_f32_16x16x32_bf16 v[32:35], v[156:159], v[200:203], v[32:35]
    ds_read_b128 v[184:187], v11 offset:14336
    s_waitcnt lgkmcnt(6)
    v_mfma_f32_16x16x32_bf16 v[36:39], v[160:163], v[196:199], v[36:39]
    v_fma_f32 v205, v4, v221, -v205
    v_fma_f32 v206, v4, v222, -v206
    v_mfma_f32_16x16x32_bf16 v[40:43], v[160:163], v[200:203], v[40:43]
    v_fma_f32 v207, v4, v223, -v207
    s_waitcnt lgkmcnt(5)
    v_mfma_f32_16x16x32_bf16 v[44:47], v[164:167], v[196:199], v[44:47]
    ds_read_b128 v[156:159], v11 offset:16384
    v_fma_f32 v208, v4, v224, -v208
    v_mfma_f32_16x16x32_bf16 v[48:51], v[164:167], v[200:203], v[48:51]
    ds_read_b128 v[160:163], v11 offset:18432
    s_waitcnt lgkmcnt(6)
    v_mfma_f32_16x16x32_bf16 v[52:55], v[168:171], v[196:199], v[52:55]
    v_fma_f32 v209, v4, v225, -v209
    v_fma_f32 v210, v4, v226, -v210
    v_mfma_f32_16x16x32_bf16 v[56:59], v[168:171], v[200:203], v[56:59]
    v_fma_f32 v211, v4, v227, -v211
    s_waitcnt lgkmcnt(5)
    v_mfma_f32_16x16x32_bf16 v[60:63], v[172:175], v[196:199], v[60:63]
    ds_read_b128 v[164:167], v11 offset:20480
    v_fma_f32 v212, v4, v228, -v212
    v_mfma_f32_16x16x32_bf16 v[64:67], v[172:175], v[200:203], v[64:67]
    ds_read_b128 v[168:171], v11 offset:22528
    s_waitcnt lgkmcnt(6)
    v_mfma_f32_16x16x32_bf16 v[68:71], v[176:179], v[196:199], v[68:71]
    v_fma_f32 v213, v4, v229, -v213
    v_fma_f32 v214, v4, v230, -v214
    v_mfma_f32_16x16x32_bf16 v[72:75], v[176:179], v[200:203], v[72:75]
    v_fma_f32 v215, v4, v231, -v215
    s_waitcnt lgkmcnt(5)
    v_mfma_f32_16x16x32_bf16 v[76:79], v[180:183], v[196:199], v[76:79]
    ds_read_b128 v[172:175], v11 offset:24576
    v_fma_f32 v216, v4, v232, -v216
    v_mfma_f32_16x16x32_bf16 v[80:83], v[180:183], v[200:203], v[80:83]
    ds_read_b128 v[176:179], v11 offset:26624
    s_waitcnt lgkmcnt(6)
    v_mfma_f32_16x16x32_bf16 v[84:87], v[184:187], v[196:199], v[84:87]
    v_fma_f32 v217, v4, v233, -v217
    v_fma_f32 v218, v4, v234, -v218
    v_mfma_f32_16x16x32_bf16 v[88:91], v[184:187], v[200:203], v[88:91]
    v_fma_f32 v219, v4, v235, -v219
    s_waitcnt lgkmcnt(5)
    v_mfma_f32_16x16x32_bf16 v[92:95], v[156:159], v[196:199], v[92:95]
    ds_read_b128 v[180:183], v11 offset:28672
    v_cvt_pk_bf16_f32 v188, v204, v205
    v_mfma_f32_16x16x32_bf16 v[96:99], v[156:159], v[200:203], v[96:99]
    ds_read_b128 v[184:187], v11 offset:30720
    s_waitcnt lgkmcnt(6)
    v_mfma_f32_16x16x32_bf16 v[100:103], v[160:163], v[196:199], v[100:103]
    v_cvt_pk_bf16_f32 v189, v206, v207
    v_cvt_pk_bf16_f32 v190, v208, v209
    v_mfma_f32_16x16x32_bf16 v[104:107], v[160:163], v[200:203], v[104:107]
    v_cvt_pk_bf16_f32 v191, v210, v211
    s_waitcnt lgkmcnt(5)
    v_mfma_f32_16x16x32_bf16 v[108:111], v[164:167], v[196:199], v[108:111]
    v_add_u32 v10, s50, v8
    v_xor_b32 v11, 64, v10
    v_mfma_f32_16x16x32_bf16 v[112:115], v[164:167], v[200:203], v[112:115]
    v_cvt_pk_bf16_f32 v192, v212, v213
    s_waitcnt lgkmcnt(4)
    v_mfma_f32_16x16x32_bf16 v[116:119], v[168:171], v[196:199], v[116:119]
    v_cvt_pk_bf16_f32 v193, v214, v215
    v_cvt_pk_bf16_f32 v194, v216, v217
    v_mfma_f32_16x16x32_bf16 v[120:123], v[168:171], v[200:203], v[120:123]
    v_cvt_pk_bf16_f32 v195, v218, v219
    s_cmp_lt_u32 s54, 2
    s_waitcnt lgkmcnt(0)
    s_cbranch_scc1 A_DL1
    s_barrier
A_DL1:
    v_mfma_f32_16x16x32_bf16 v[124:127], v[172:175], v[196:199], v[124:127]
    ds_read_b128 v[156:159], v10 offset:0
    v_mfma_f32_16x16x32_bf16 v[128:131], v[172:175], v[200:203], v[128:131]
    ds_read_b128 v[160:163], v10 offset:2048
    v_mfma_f32_16x16x32_bf16 v[132:135], v[176:179], v[196:199], v[132:135]
    ds_read_b128 v[164:167], v10 offset:4096
    v_mfma_f32_16x16x32_bf16 v[136:139], v[176:179], v[200:203], v[136:139]
    ds_read_b128 v[168:171], v10 offset:6144
    v_mfma_f32_16x16x32_bf16 v[140:143], v[180:183], v[196:199], v[140:143]
    ds_read_b128 v[172:175], v10 offset:8192
    s_cmp_lg_u32 s54, 0
    v_mfma_f32_16x16x32_bf16 v[144:147], v[180:183], v[200:203], v[144:147]
    ds_read_b128 v[176:179], v10 offset:10240
    v_mfma_f32_16x16x32_bf16 v[148:151], v[184:187], v[196:199], v[148:151]
    v_mfma_f32_16x16x32_bf16 v[152:155], v[184:187], v[200:203], v[152:155]
    s_cbranch_scc1 A_DL
A_DLE:
    s_mov_b64 exec, 1
    ds_add_u32 v16, v21
    s_mov_b64 exec, -1
    v_pk_fma_f32 v[28:29], v[92:93], v[252:253], v[28:29]
    v_pk_fma_f32 v[30:31], v[94:95], v[252:253], v[30:31]
    v_pk_fma_f32 v[32:33], v[96:97], v[252:253], v[32:33]
    v_pk_fma_f32 v[34:35], v[98:99], v[252:253], v[34:35]
    v_pk_fma_f32 v[36:37], v[100:101], v[252:253], v[36:37]
    v_pk_fma_f32 v[38:39], v[102:103], v[252:253], v[38:39]
    v_pk_fma_f32 v[40:41], v[104:105], v[252:253], v[40:41]
    v_pk_fma_f32 v[42:43], v[106:107], v[252:253], v[42:43]
    v_pk_fma_f32 v[44:45], v[108:109], v[252:253], v[44:45]
    v_pk_fma_f32 v[46:47], v[110:111], v[252:253], v[46:47]
    v_pk_fma_f32 v[48:49], v[112:113], v[252:253], v[48:49]
    v_pk_fma_f32 v[50:51], v[114:115], v[252:253], v[50:51]
    v_pk_fma_f32 v[52:53], v[116:117], v[252:253], v[52:53]
    v_pk_fma_f32 v[54:55], v[118:119], v[252:253], v[54:55]
    v_pk_fma_f32 v[56:57], v[120:121], v[252:253], v[56:57]
    v_pk_fma_f32 v[58:59], v[122:123], v[252:253], v[58:59]
    v_pk_fma_f32 v[60:61], v[124:125], v[252:253], v[60:61]
    v_pk_fma_f32 v[62:63], v[126:127], v[252:253], v[62:63]
    v_pk_fma_f32 v[64:65], v[128:129], v[252:253], v[64:65]
    v_pk_fma_f32 v[66:67], v[130:131], v[252:253], v[66:67]
    v_pk_fma_f32 v[68:69], v[132:133], v[252:253], v[68:69]
    v_pk_fma_f32 v[70:71], v[134:135], v[252:253], v[70:71]
    v_pk_fma_f32 v[72:73], v[136:137], v[252:253], v[72:73]
    v_pk_fma_f32 v[74:75], v[138:139], v[252:253], v[74:75]
    v_pk_fma_f32 v[76:77], v[140:141], v[252:253], v[76:77]
    v_pk_fma_f32 v[78:79], v[142:143], v[252:253], v[78:79]
    v_pk_fma_f32 v[80:81], v[144:145], v[252:253], v[80:81]
    v_pk_fma_f32 v[82:83], v[146:147], v[252:253], v[82:83]
    v_pk_fma_f32 v[84:85], v[148:149], v[252:253], v[84:85]
    v_pk_fma_f32 v[86:87], v[150:151], v[252:253], v[86:87]
    v_pk_fma_f32 v[88:89], v[152:153], v[252:253], v[88:89]
    v_pk_fma_f32 v[90:91], v[154:155], v[252:253], v[90:91]
    s_mov_b32 s61, 4000000
A_DS:
    ds_read_b32 v17, v16
    ds_read_b128 v[156:159], v13 offset:0
    ds_read_b128 v[160:163], v13 offset:1024
    ds_read_b128 v[164:167], v13 offset:2048
    ds_read_b128 v[168:171], v13 offset:3072
    ds_read_b128 v[172:175], v13 offset:4096
    ds_read_b128 v[176:179], v13 offset:5120
    ds_read_b128 v[180:183], v13 offset:6144
    ds_read_b128 v[184:187], v13 offset:7168
    ds_read_b128 v[188:191], v13 offset:8192
    ds_read_b128 v[192:195], v13 offset:9216
    ds_read_b128 v[196:199], v13 offset:10240
    ds_read_b128 v[200:203], v13 offset:11264
    ds_read_b128 v[204:207], v13 offset:12288
    ds_read_b128 v[208:211], v13 offset:13312
    ds_read_b128 v[212:215], v13 offset:14336
    ds_read_b128 v[216:219], v13 offset:15360
    v_cvt_pk_bf16_f32 v92, v28, v29
    v_cvt_pk_bf16_f32 v93, v30, v31
    v_cvt_pk_bf16_f32 v94, v36, v37
    v_cvt_pk_bf16_f32 v95, v38, v39
    v_cvt_pk_bf16_f32 v96, v32, v33
    v_cvt_pk_bf16_f32 v97, v34, v35
    v_cvt_pk_bf16_f32 v98, v40, v41
    v_cvt_pk_bf16_f32 v99, v42, v43
    v_xor_b32 v100, s70, v92
    v_xor_b32 v101, s70, v93
    v_xor_b32 v102, s70, v94
    v_xor_b32 v103, s70, v95
    v_cvt_pk_bf16_f32 v104, v44, v45
    v_cvt_pk_bf16_f32 v105, v46, v47
    v_cvt_pk_bf16_f32 v106, v52, v53
    v_cvt_pk_bf16_f32 v107, v54, v55
    v_cvt_pk_bf16_f32 v108, v48, v49
    v_cvt_pk_bf16_f32 v109, v50, v51
    v_cvt_pk_bf16_f32 v110, v56, v57
    v_cvt_pk_bf16_f32 v111, v58, v59
    v_xor_b32 v112, s70, v104
    v_xor_b32 v113, s70, v105
    v_xor_b32 v114, s70, v106
    v_xor_b32 v115, s70, v107
    s_waitcnt lgkmcnt(15)
    v_readfirstlane_b32 s60, v17
    s_nop 1
    s_and_b32 s60, s60, 255
    s_cmp_ge_u32 s60, 8
    s_cbranch_scc1 A_DS1
    s_sub_u32 s61, s61, 1
    s_cmp_lg_u32 s61, 0
    s_waitcnt lgkmcnt(0)
    s_sleep 2
    s_cbranch_scc1 A_DS
A_DS1:
    s_waitcnt lgkmcnt(15)
    v_mfma_f32_16x16x32_bf16 v[28:31], v[92:95], v[156:159], 0
    v_cvt_pk_bf16_f32 v116, v60, v61
    v_cvt_pk_bf16_f32 v117, v62, v63
    v_mfma_f32_16x16x32_bf16 v[32:35], v[96:99], v[156:159], 0
    v_cvt_pk_bf16_f32 v118, v68, v69
    s_waitcnt lgkmcnt(14)
    v_mfma_f32_16x16x32_bf16 v[28:31], v[96:99], v[160:163], v[28:31]
    v_cvt_pk_bf16_f32 v119, v70, v71
    v_cvt_pk_bf16_f32 v120, v64, v65
    v_mfma_f32_16x16x32_bf16 v[32:35], v[100:103], v[160:163], v[32:35]
    v_cvt_pk_bf16_f32 v121, v66, v67
    s_waitcnt lgkmcnt(13)
    v_mfma_f32_16x16x32_bf16 v[36:39], v[92:95], v[164:167], 0
    v_cvt_pk_bf16_f32 v122, v72, v73
    v_cvt_pk_bf16_f32 v123, v74, v75
    v_mfma_f32_16x16x32_bf16 v[40:43], v[96:99], v[164:167], 0
    v_xor_b32 v124, s70, v116
    s_waitcnt lgkmcnt(12)
    v_mfma_f32_16x16x32_bf16 v[36:39], v[96:99], v[168:171], v[36:39]
    v_xor_b32 v125, s70, v117
    v_xor_b32 v126, s70, v118
    v_mfma_f32_16x16x32_bf16 v[40:43], v[100:103], v[168:171], v[40:43]
    v_xor_b32 v127, s70, v119
    s_waitcnt lgkmcnt(11)
    v_mfma_f32_16x16x32_bf16 v[44:47], v[104:107], v[172:175], 0
    v_cvt_pk_bf16_f32 v128, v76, v77
    v_cvt_pk_bf16_f32 v129, v78, v79
    v_mfma_f32_16x16x32_bf16 v[48:51], v[108:111], v[172:175], 0
    v_cvt_pk_bf16_f32 v130, v84, v85
    s_waitcnt lgkmcnt(10)
    v_mfma_f32_16x16x32_bf16 v[44:47], v[108:111], v[176:179], v[44:47]
    v_cvt_pk_bf16_f32 v131, v86, v87
    v_cvt_pk_bf16_f32 v132, v80, v81
    v_mfma_f32_16x16x32_bf16 v[48:51], v[112:115], v[176:179], v[48:51]
    v_cvt_pk_bf16_f32 v133, v82, v83
    s_waitcnt lgkmcnt(9)
    v_mfma_f32_16x16x32_bf16 v[52:55], v[104:107], v[180:183], 0
    v_cvt_pk_bf16_f32 v134, v88, v89
    v_cvt_pk_bf16_f32 v135, v90, v91
    v_mfma_f32_16x16x32_bf16 v[56:59], v[108:111], v[180:183], 0
    v_xor_b32 v136, s70, v128
    s_waitcnt lgkmcnt(8)
    v_mfma_f32_16x16x32_bf16 v[52:55], v[108:111], v[184:187], v[52:55]
    v_xor_b32 v137, s70, v129
    v_xor_b32 v138, s70, v130
    v_mfma_f32_16x16x32_bf16 v[56:59], v[112:115], v[184:187], v[56:59]
    v_xor_b32 v139, s70, v131
    s_waitcnt lgkmcnt(7)
    v_mfma_f32_16x16x32_bf16 v[60:63], v[116:119], v[188:191], 0
    v_cvt_pk_bf16_f32 v220, v28, v29
    v_cvt_pk_bf16_f32 v221, v30, v31
    v_mfma_f32_16x16x32_bf16 v[64:67], v[120:123], v[188:191], 0
    v_cvt_pk_bf16_f32 v222, v32, v33
    v_cvt_pk_bf16_f32 v223, v34, v35
    s_waitcnt lgkmcnt(6)
    v_mfma_f32_16x16x32_bf16 v[60:63], v[120:123], v[192:195], v[60:63]
    ds_write_b128 v14, v[220:223] offset:0
    v_cvt_pk_bf16_f32 v224, v36, v37
    v_mfma_f32_16x16x32_bf16 v[64:67], v[124:127], v[192:195], v[64:67]
    v_cvt_pk_bf16_f32 v225, v38, v39
    v_cvt_pk_bf16_f32 v226, v40, v41
    s_waitcnt lgkmcnt(6)
    v_mfma_f32_16x16x32_bf16 v[68:71], v[116:119], v[196:199], 0
    v_cvt_pk_bf16_f32 v227, v42, v43
    ds_write_b128 v14, v[224:227] offset:4096
    v_mfma_f32_16x16x32_bf16 v[72:75], v[120:123], v[196:199], 0
    v_cvt_pk_bf16_f32 v228, v44, v45
    v_cvt_pk_bf16_f32 v229, v46, v47
    s_waitcnt lgkmcnt(6)
    v_mfma_f32_16x16x32_bf16 v[68:71], v[120:123], v[200:203], v[68:71]
    v_cvt_pk_bf16_f32 v230, v48, v49
    v_cvt_pk_bf16_f32 v231, v50, v51
    v_mfma_f32_16x16x32_bf16 v[72:75], v[124:127], v[200:203], v[72:75]
    ds_write_b128 v15, v[228:231] offset:0
    s_waitcnt lgkmcnt(6)
    v_mfma_f32_16x16x32_bf16 v[76:79], v[128:131], v[204:207], 0
    v_cvt_pk_bf16_f32 v232, v52, v53
    v_cvt_pk_bf16_f32 v233, v54, v55
    v_mfma_f32_16x16x32_bf16 v[80:83], v[132:135], v[204:207], 0
    v_cvt_pk_bf16_f32 v234, v56, v57
    v_cvt_pk_bf16_f32 v235, v58, v59
    s_waitcnt lgkmcnt(5)
    v_mfma_f32_16x16x32_bf16 v[76:79], v[132:135], v[208:211], v[76:79]
    ds_write_b128 v15, v[232:235] offset:4096
    v_cvt_pk_bf16_f32 v236, v60, v61
    v_mfma_f32_16x16x32_bf16 v[80:83], v[136:139], v[208:211], v[80:83]
    v_cvt_pk_bf16_f32 v237, v62, v63
    v_cvt_pk_bf16_f32 v238, v64, v65
    s_waitcnt lgkmcnt(5)
    v_mfma_f32_16x16x32_bf16 v[84:87], v[128:131], v[212:215], 0
    v_cvt_pk_bf16_f32 v239, v66, v67
    ds_write_b128 v14, v[236:239] offset:128
    v_mfma_f32_16x16x32_bf16 v[88:91], v[132:135], v[212:215], 0
    v_cvt_pk_bf16_f32 v240, v68, v69
    v_cvt_pk_bf16_f32 v241, v70, v71
    s_waitcnt lgkmcnt(5)
    v_mfma_f32_16x16x32_bf16 v[84:87], v[132:135], v[216:219], v[84:87]
    v_cvt_pk_bf16_f32 v242, v72, v73
    v_cvt_pk_bf16_f32 v243, v74, v75
    v_mfma_f32_16x16x32_bf16 v[88:91], v[136:139], v[216:219], v[88:91]
    ds_write_b128 v14, v[240:243] offset:4224
    v_cvt_pk_bf16_f32 v244, v76, v77
    v_cvt_pk_bf16_f32 v245, v78, v79
    v_cvt_pk_bf16_f32 v246, v80, v81
    v_cvt_pk_bf16_f32 v247, v82, v83
    ds_write_b128 v15, v[244:247] offset:128
    v_cvt_pk_bf16_f32 v248, v84, v85
    v_cvt_pk_bf16_f32 v249, v86, v87
    v_cvt_pk_bf16_f32 v250, v88, v89
    v_cvt_pk_bf16_f32 v251, v90, v91
    ds_write_b128 v15, v[248:251] offset:4224
    s_waitcnt lgkmcnt(0)
    ds_read_b128 v[156:159], v18 offset:0
    ds_read_b128 v[160:163], v19 offset:1024
    ds_read_b128 v[164:167], v18 offset:2048
    ds_read_b128 v[168:171], v19 offset:3072
    ds_read_b128 v[172:175], v18 offset:4096
    ds_read_b128 v[176:179], v19 offset:5120
    ds_read_b128 v[180:183], v18 offset:6144
    ds_read_b128 v[184:187], v19 offset:7168
    s_waitcnt lgkmcnt(7)
    buffer_store_dwordx4 v[156:159], v20, s[28:31], s65 offen sc1
    s_add_u32 s65, s65, 327680
    s_waitcnt lgkmcnt(6)
    buffer_store_dwordx4 v[160:163], v20, s[28:31], s65 offen sc1
    s_add_u32 s65, s65, 327680
    s_waitcnt lgkmcnt(5)
    buffer_store_dwordx4 v[164:167], v20, s[28:31], s65 offen sc1
    s_add_u32 s65, s65, 327680
    s_waitcnt lgkmcnt(4)
    buffer_store_dwordx4 v[168:171], v20, s[28:31], s65 offen sc1
    s_add_u32 s65, s65, 327680
    s_waitcnt lgkmcnt(3)
    buffer_store_dwordx4 v[172:175], v20, s[28:31], s65 offen sc1
    s_add_u32 s65, s65, 327680
    s_waitcnt lgkmcnt(2)
    buffer_store_dwordx4 v[176:179], v20, s[28:31], s65 offen sc1
    s_add_u32 s65, s65, 327680
    s_waitcnt lgkmcnt(1)
    buffer_store_dwordx4 v[180:183], v20, s[28:31], s65 offen sc1
    s_add_u32 s65, s65, 327680
    s_waitcnt lgkmcnt(0)
    buffer_store_dwordx4 v[184:187], v20, s[28:31], s65 offen sc1
    s_add_u32 s65, s65, 327680
    s_mov_b64 exec, 1
    ds_add_u32 v16, v21
    s_mov_b64 exec, -1
    s_mov_b32 s38, 0
    s_mov_b32 s66, 1
    s_waitcnt vmcnt(0)
    s_atomic_add s66, s[56:57], s64
B_COMPUTE:
    s_cmp_ge_u32 s45, s47
    s_cselect_b32 s53, 1, 9
    s_lshr_b32 s42, s41, 3
    s_lshl_b32 s33, s40, 2
    s_add_u32 s33, s33, s42
    s_and_b32 s34, s41, 7
    v_lshlrev_b32 v3, 4, v0
    s_load_dwordx2 s[8:9], s[0:1], 64
    s_add_u32 s56, s14, 20971520
    s_addc_u32 s57, s15, 0
    s_lshl_b32 s38, s38, 8
    s_and_b32 s44, s32, 1
    s_lshr_b32 s45, s32, 1
    s_lshl_b32 s55, s33, 1
    s_add_u32 s55, s55, s44
    s_lshl_b32 s49, s45, 10
    s_add_u32 s49, s55, s49
    s_brev_b32 s67, 1
    v_lshlrev_b32 v9, 3, v2
    v_cvt_f32_u32 v9, v9
    v_lshl_add_u32 v10, v1, 6, s49
    v_cvt_f32_u32 v10, v10
    v_mul_f32 v10, 0x3a000000, v10
    v_mul_f32 v228, v10, v9
    v_add_f32 v229, v10, v228
    v_add_f32 v230, v10, v229
    v_add_f32 v231, v10, v230
    v_add_f32 v232, v10, v231
    v_add_f32 v233, v10, v232
    v_add_f32 v234, v10, v233
    v_add_f32 v235, v10, v234
    v_sin_f32 v236, v228
    v_cos_f32 v228, v228
    v_sin_f32 v237, v229
    v_cos_f32 v229, v229
    v_sin_f32 v238, v230
    v_cos_f32 v230, v230
    v_sin_f32 v239, v231
    v_cos_f32 v231, v231
    v_sin_f32 v240, v232
    v_cos_f32 v232, v232
    v_sin_f32 v241, v233
    v_cos_f32 v233, v233
    v_sin_f32 v242, v234
    v_cos_f32 v234, v234
    v_sin_f32 v243, v235
    v_cos_f32 v235, v235
    v_cvt_pk_bf16_f32 v12, v228, v229
    v_cvt_pk_bf16_f32 v16, v236, v237
    v_cvt_pk_bf16_f32 v13, v230, v231
    v_cvt_pk_bf16_f32 v17, v238, v239
    v_cvt_pk_bf16_f32 v14, v232, v233
    v_cvt_pk_bf16_f32 v18, v240, v241
    v_cvt_pk_bf16_f32 v15, v234, v235
    v_cvt_pk_bf16_f32 v19, v242, v243
    v_xor_b32 v20, s67, v12
    v_xor_b32 v21, s67, v13
    v_xor_b32 v22, s67, v14
    v_xor_b32 v23, s67, v15
    v_xor_b32 v24, s67, v16
    v_xor_b32 v25, s67, v17
    v_xor_b32 v26, s67, v18
    v_xor_b32 v27, s67, v19
    s_mov_b32 s52, 429496730
    v_add_u32 v9, 0, v0
    v_mul_hi_u32 v10, v9, s52
    v_mul_u32_u24 v11, 10, v10
    v_sub_u32 v11, v9, v11
    v_cmp_le_u32 vcc, 5, v11
    v_add_u32 v9, 35, v11
    s_nop 0
    v_cndmask_b32 v11, v11, v9, vcc
    v_mul_u32_u24 v10, 81920, v10
    v_lshl_add_u32 v249, v11, 4, v10
    v_add_u32 v9, 64, v0
    v_mul_hi_u32 v10, v9, s52
    v_mul_u32_u24 v11, 10, v10
    v_sub_u32 v11, v9, v11
    v_cmp_le_u32 vcc, 5, v11
    v_add_u32 v9, 35, v11
    s_nop 0
    v_cndmask_b32 v11, v11, v9, vcc
    v_mul_u32_u24 v10, 81920, v10
    v_lshl_add_u32 v250, v11, 4, v10
    v_add_u32 v9, 128, v0
    v_mul_hi_u32 v10, v9, s52
    v_mul_u32_u24 v11, 10, v10
    v_sub_u32 v11, v9, v11
    v_cmp_le_u32 vcc, 5, v11
    v_add_u32 v9, 35, v11
    s_nop 0
    v_cndmask_b32 v11, v11, v9, vcc
    v_mul_u32_u24 v10, 81920, v10
    v_lshl_add_u32 v251, v11, 4, v10
    s_mul_i32 s50, s45, 5120
    v_add_u32 v7, s50, v3
    s_lshl_b32 s50, s45, 12
    s_lshl_b32 s51, s44, 11
    s_add_u32 s51, s51, s50
    s_lshl_b32 s52, s45, 10
    s_add_u32 s51, s51, s52
    s_add_u32 s51, s51, 81920
    v_add_u32 v252, s51, v3
    v_lshrrev_b32 v9, 2, v1
    v_lshl_add_u32 v9, v2, 3, v9
    v_lshlrev_b32 v9, 7, v9
    v_and_b32 v10, 3, v1
    v_lshl_add_u32 v9, v10, 4, v9
    s_lshl_b32 s51, s44, 6
    v_add_u32 v9, s51, v9
    v_and_b32 v10, 8, v1
    v_lshlrev_b32 v10, 3, v10
    v_xor_b32 v9, v9, v10
    s_add_u32 s50, s50, 98304
    v_add_u32 v8, s50, v9
    s_mul_i32 s54, s34, 80
    s_mul_i32 s59, s49, 1280
    s_add_u32 s59, s59, s54
    s_mul_i32 s58, s32, 2560
    s_add_u32 s58, s58, 98304
    s_cmp_eq_u32 s32, 3
    s_cselect_b32 s58, 124160, s58
    s_mov_b32 s70, 0x80008000
    s_mov_b32 s69, 0xffff0000
    s_mov_b32 s66, 1
    s_waitcnt vmcnt(0) lgkmcnt(0)
    s_cmp_eq_u32 s38, 0
    s_cbranch_scc1 B_NA
    s_atomic_add s66, s[56:57], s38
B_NA:
    s_mov_b64 s[20:21], s[8:9]
    s_mov_b32 s22, 2621440
    s_mov_b32 s23, 0x20000
    s_mul_i32 s50, s34, 40
    v_lshl_add_u32 v68, v2, 3, s45
    v_cvt_f32_u32 v68, v68
    v_add_u32 v69, s50, v1
    v_cvt_f32_u32 v69, v69
    v_and_b32 v9, 8, v1
    v_cvt_f32_u32 v9, v9
    v_fmamk_f32 v70, v9, 0xc2240000, v69
    v_add_f32 v9, 0x3f000000, v69
    v_mul_f32 v9, 0xbacccccd, v9
    v_mul_f32 v10, v68, v9
    v_mul_f32 v244, 0x42000000, v9
    v_cos_f32 v244, v244
    v_fmamk_f32 v164, v9, 0xc1f80000, v10
    v_fmamk_f32 v165, v9, 0xc1e80000, v10
    v_fmamk_f32 v166, v9, 0xc1d80000, v10
    v_fmamk_f32 v167, v9, 0xc1c80000, v10
    v_fmamk_f32 v172, v9, 0xc27c0000, v10
    v_fmamk_f32 v173, v9, 0xc2740000, v10
    v_fmamk_f32 v174, v9, 0xc26c0000, v10
    v_fmamk_f32 v175, v9, 0xc2640000, v10
    v_add_f32 v244, v244, v244
    v_sin_f32 v168, v164
    v_cos_f32 v164, v164
    v_sin_f32 v169, v165
    v_cos_f32 v165, v165
    v_sin_f32 v170, v166
    v_cos_f32 v166, v166
    v_sin_f32 v171, v167
    v_cos_f32 v167, v167
    v_sin_f32 v176, v172
    v_cos_f32 v172, v172
    v_sin_f32 v177, v173
    v_cos_f32 v173, v173
    v_sin_f32 v178, v174
    v_cos_f32 v174, v174
    v_sin_f32 v179, v175
    v_cos_f32 v175, v175
    v_add_f32 v9, 0x41840000, v69
    v_mul_f32 v9, 0xbacccccd, v9
    v_mul_f32 v10, v68, v9
    v_mul_f32 v245, 0x42000000, v9
    v_cos_f32 v245, v245
    v_fmamk_f32 v180, v9, 0xc1f80000, v10
    v_fmamk_f32 v181, v9, 0xc1e80000, v10
    v_fmamk_f32 v182, v9, 0xc1d80000, v10
    v_fmamk_f32 v183, v9, 0xc1c80000, v10
    v_fmamk_f32 v188, v9, 0xc27c0000, v10
    v_fmamk_f32 v189, v9, 0xc2740000, v10
    v_fmamk_f32 v190, v9, 0xc26c0000, v10
    v_fmamk_f32 v191, v9, 0xc2640000, v10
    v_add_f32 v245, v245, v245
    v_sin_f32 v184, v180
    v_cos_f32 v180, v180
    v_sin_f32 v185, v181
    v_cos_f32 v181, v181
    v_sin_f32 v186, v182
    v_cos_f32 v182, v182
    v_sin_f32 v187, v183
    v_cos_f32 v183, v183
    v_sin_f32 v192, v188
    v_cos_f32 v188, v188
    v_sin_f32 v193, v189
    v_cos_f32 v189, v189
    v_sin_f32 v194, v190
    v_cos_f32 v190, v190
    v_sin_f32 v195, v191
    v_cos_f32 v191, v191
    v_add_f32 v9, 0x42020000, v70
    v_mul_f32 v9, 0xbacccccd, v9
    v_mul_f32 v10, v68, v9
    v_mul_f32 v246, 0x42000000, v9
    v_cos_f32 v246, v246
    v_fmamk_f32 v196, v9, 0xc1f80000, v10
    v_fmamk_f32 v197, v9, 0xc1e80000, v10
    v_fmamk_f32 v198, v9, 0xc1d80000, v10
    v_fmamk_f32 v199, v9, 0xc1c80000, v10
    v_fmamk_f32 v204, v9, 0xc27c0000, v10
    v_fmamk_f32 v205, v9, 0xc2740000, v10
    v_fmamk_f32 v206, v9, 0xc26c0000, v10
    v_fmamk_f32 v207, v9, 0xc2640000, v10
    v_add_f32 v246, v246, v246
    v_sin_f32 v200, v196
    v_cos_f32 v196, v196
    v_sin_f32 v201, v197
    v_cos_f32 v197, v197
    v_sin_f32 v202, v198
    v_cos_f32 v198, v198
    v_sin_f32 v203, v199
    v_cos_f32 v199, v199
    v_sin_f32 v208, v204
    v_cos_f32 v204, v204
    v_sin_f32 v209, v205
    v_cos_f32 v205, v205
    v_sin_f32 v210, v206
    v_cos_f32 v206, v206
    v_sin_f32 v211, v207
    v_cos_f32 v207, v207
    v_mov_b32 v212, 0
    v_mov_b32 v213, 0
    v_mov_b32 v214, 0
    v_mov_b32 v215, 0
    v_mov_b32 v216, 0
    v_mov_b32 v217, 0
    v_mov_b32 v218, 0
    v_mov_b32 v219, 0
    v_mov_b32 v220, 0
    v_mov_b32 v221, 0
    v_mov_b32 v222, 0
    v_mov_b32 v223, 0
    v_mov_b32 v224, 0
    v_mov_b32 v225, 0
    v_mov_b32 v226, 0
    v_mov_b32 v227, 0
    v_mov_b32 v32, 0
    v_mov_b32 v33, 0
    v_mov_b32 v34, 0
    v_mov_b32 v35, 0
    v_mov_b32 v40, 0
    v_mov_b32 v41, 0
    v_mov_b32 v42, 0
    v_mov_b32 v43, 0
    v_mov_b32 v48, 0
    v_mov_b32 v49, 0
    v_mov_b32 v50, 0
    v_mov_b32 v51, 0
    v_mov_b32 v56, 0
    v_mov_b32 v57, 0
    v_mov_b32 v58, 0
    v_mov_b32 v59, 0
    v_mov_b32 v64, 0
    v_mov_b32 v65, 0
    v_mov_b32 v66, 0
    v_mov_b32 v67, 0
    v_mul_u32_u24 v11, 160, v1
    v_lshl_add_u32 v11, v2, 3, v11
    v_add_u32 v253, s58, v11
    v_lshlrev_b32 v10, 3, v2
    v_add_u32 v10, 105984, v10
    v_and_b32 v254, 2, v2
    v_lshlrev_b32 v254, 5, v254
    v_add_u32 v152, v253, v254
    v_add_u32 v153, v10, v254
    s_mov_b32 s46, 0
    s_mov_b32 s47, 0
    s_cmp_gt_u32 s32, 1
    s_cbranch_scc1 B_NP
    s_cmp_lg_u32 s53, 1
    s_cbranch_scc1 B_NP
    v_mov_b32 v4, 159744
    s_mov_b32 s61, 4000000
L_20:
    ds_read_b32 v5, v4
    s_waitcnt lgkmcnt(0)
    v_readfirstlane_b32 s60, v5
    s_nop 1
    s_bfe_u32 s60, s60, 524288
    s_cmp_ge_u32 s60, 12
    s_cbranch_scc1 L_21
    s_sub_u32 s61, s61, 1
    s_cmp_lg_u32 s61, 0
    s_sleep 1
    s_cbranch_scc1 L_20
L_21:
    s_cmp_eq_u32 s32, 0
    s_cbranch_scc1 B_P0
    v_add_u32 v4, 4096, v3
    v_add_u32 v5, 8192, v3
    s_mov_b32 s62, 0
    s_mov_b32 s64, 0
    s_add_u32 s65, s33, 80
    s_lshl_b32 s65, s65, 8
    s_mul_i32 s50, s34, 276480
    s_add_u32 s50, s50, 8388608
    s_add_u32 s28, s14, s50
    s_addc_u32 s29, s15, 0
    s_mov_b32 s30, 276480
    s_mov_b32 s31, 0x20000
    s_mov_b32 s61, 100000
L_22:
    s_mov_b32 s60, 0
    s_atomic_add s60, s[56:57], s65 glc
L_24:
    s_waitcnt lgkmcnt(0)
    s_bfe_u32 s60, s60, 524304
    s_cmp_eq_u32 s60, 8
    s_cbranch_scc1 L_23
    s_sub_u32 s61, s61, 1
    s_cmp_eq_u32 s61, 0
    s_cbranch_scc1 L_23
    s_sleep 2
    s_branch L_22
L_23:
B_PWDG:
B_PWD:
    s_add_u32 m0, s64, 0
    s_nop 0
    buffer_load_dwordx4 v3, s[28:31], s62 offen offset:0 sc1 lds
    buffer_load_dwordx4 v3, s[28:31], s62 offen offset:1024 sc1 lds
    buffer_load_dwordx4 v3, s[28:31], s62 offen offset:2048 sc1 lds
    buffer_load_dwordx4 v3, s[28:31], s62 offen offset:3072 sc1 lds
    s_add_u32 m0, s64, 4096
    s_nop 0
    buffer_load_dwordx4 v4, s[28:31], s62 offen offset:0 sc1 lds
    buffer_load_dwordx4 v4, s[28:31], s62 offen offset:1024 sc1 lds
    buffer_load_dwordx4 v4, s[28:31], s62 offen offset:2048 sc1 lds
    buffer_load_dwordx4 v4, s[28:31], s62 offen offset:3072 sc1 lds
    s_add_u32 m0, s64, 8192
    s_nop 0
    buffer_load_dwordx4 v5, s[28:31], s62 offen offset:0 sc1 lds
    buffer_load_dwordx4 v5, s[28:31], s62 offen offset:1024 sc1 lds
    s_add_u32 s62, s62, 10240
    s_add_u32 s64, s64, 10240
    s_cmp_lt_u32 s64, 71680
    s_waitcnt vmcnt(60)
    s_cbranch_scc1 B_PWD
    s_branch B_P1
B_P0:
    s_load_dwordx2 s[10:11], s[0:1], 56
    s_mul_i32 s54, s34, 80
    s_mul_i32 s63, s33, 2560
    s_add_u32 s63, s63, s54
    s_add_u32 s65, s33, 80
    s_lshl_b32 s65, s65, 8
    s_waitcnt lgkmcnt(0)
    s_mov_b64 s[28:29], s[4:5]
    s_mov_b32 s30, 2621440
    s_mov_b32 s31, 0x20000
    s_mov_b64 s[24:25], s[10:11]
    s_mov_b32 s26, 1280
    s_mov_b32 s27, 0x20000
    s_add_u32 s64, s63, 0
    s_mov_b32 m0, 98304
    s_nop 0
    buffer_load_dwordx4 v249, s[28:31], s64 offen lds
    s_mov_b32 m0, 99328
    s_nop 0
    buffer_load_dwordx4 v250, s[28:31], s64 offen lds
    s_mov_b32 m0, 100352
    s_mov_b32 exec_hi, 0
    buffer_load_dwordx4 v251, s[28:31], s64 offen lds
    s_mov_b64 exec, -1
    s_add_u32 s64, s63, 1280
    s_mov_b32 m0, 100864
    s_nop 0
    buffer_load_dwordx4 v249, s[28:31], s64 offen lds
    s_mov_b32 m0, 101888
    s_nop 0
    buffer_load_dwordx4 v250, s[28:31], s64 offen lds
    s_mov_b32 m0, 102912
    s_mov_b32 exec_hi, 0
    buffer_load_dwordx4 v251, s[28:31], s64 offen lds
    s_mov_b64 exec, -1
    s_add_u32 s64, s63, 1310720
    s_mov_b32 m0, 103424
    s_nop 0
    buffer_load_dwordx4 v249, s[28:31], s64 offen lds
    s_mov_b32 m0, 104448
    s_nop 0
    buffer_load_dwordx4 v250, s[28:31], s64 offen lds
    s_mov_b32 m0, 105472
    s_mov_b32 exec_hi, 0
    buffer_load_dwordx4 v251, s[28:31], s64 offen lds
    s_mov_b64 exec, -1
    s_add_u32 s64, s63, 1312000
    s_mov_b32 m0, 124160
    s_nop 0
    buffer_load_dwordx4 v249, s[28:31], s64 offen lds
    s_mov_b32 m0, 125184
    s_nop 0
    buffer_load_dwordx4 v250, s[28:31], s64 offen lds
    s_mov_b32 m0, 126208
    s_mov_b32 exec_hi, 0
    buffer_load_dwordx4 v251, s[28:31], s64 offen lds
    s_mov_b64 exec, -1
    s_mov_b32 m0, 105984
    s_mov_b64 exec, 0x3ff
    buffer_load_dwordx4 v249, s[24:27], s54 offen lds
    s_mov_b64 exec, -1
    s_mul_i32 s50, s33, 221184
    s_add_u32 s50, s50, 0
    s_add_u32 s16, s14, s50
    s_addc_u32 s17, s15, 0
    s_mov_b32 s18, 221184
    s_mov_b32 s19, 0x20000
    v_add_u32 v4, 4096, v3
    s_mov_b32 s62, 0
    s_mov_b32 s61, 100000
L_25:
    s_mov_b32 s60, 0
    s_atomic_add s60, s[56:57], s65 glc
L_27:
    s_waitcnt lgkmcnt(0)
    s_bfe_u32 s60, s60, 524288
    s_cmp_eq_u32 s60, 22
    s_cbranch_scc1 L_26
    s_sub_u32 s61, s61, 1
    s_cmp_eq_u32 s61, 0
    s_cbranch_scc1 L_26
    s_sleep 2
    s_branch L_25
L_26:
    s_mov_b32 m0, 81920
    s_nop 0
    buffer_load_dwordx4 v3, s[16:19], s62 offen offset:0 sc1 lds
    buffer_load_dwordx4 v3, s[16:19], s62 offen offset:1024 sc1 lds
    buffer_load_dwordx4 v3, s[16:19], s62 offen offset:2048 sc1 lds
    buffer_load_dwordx4 v3, s[16:19], s62 offen offset:3072 sc1 lds
    s_mov_b32 m0, 86016
    s_nop 0
    buffer_load_dwordx4 v4, s[16:19], s62 offen offset:0 sc1 lds
    buffer_load_dwordx4 v4, s[16:19], s62 offen offset:1024 sc1 lds
    buffer_load_dwordx4 v4, s[16:19], s62 offen offset:2048 sc1 lds
    buffer_load_dwordx4 v4, s[16:19], s62 offen offset:3072 sc1 lds
    s_add_u32 s62, s62, 8192
    s_mov_b32 m0, 90112
    s_nop 0
    buffer_load_dwordx4 v3, s[16:19], s62 offen offset:0 sc1 lds
    buffer_load_dwordx4 v3, s[16:19], s62 offen offset:1024 sc1 lds
    buffer_load_dwordx4 v3, s[16:19], s62 offen offset:2048 sc1 lds
    buffer_load_dwordx4 v3, s[16:19], s62 offen offset:3072 sc1 lds
    s_mov_b32 m0, 94208
    s_nop 0
    buffer_load_dwordx4 v4, s[16:19], s62 offen offset:0 sc1 lds
    buffer_load_dwordx4 v4, s[16:19], s62 offen offset:1024 sc1 lds
    buffer_load_dwordx4 v4, s[16:19], s62 offen offset:2048 sc1 lds
    buffer_load_dwordx4 v4, s[16:19], s62 offen offset:3072 sc1 lds
    s_add_u32 s62, s62, 8192
    s_mov_b32 m0, 106496
    s_nop 0
    buffer_load_dwordx4 v3, s[16:19], s62 offen offset:0 sc1 lds
    buffer_load_dwordx4 v3, s[16:19], s62 offen offset:1024 sc1 lds
    buffer_load_dwordx4 v3, s[16:19], s62 offen offset:2048 sc1 lds
    buffer_load_dwordx4 v3, s[16:19], s62 offen offset:3072 sc1 lds
    s_mov_b32 m0, 110592
    s_nop 0
    buffer_load_dwordx4 v4, s[16:19], s62 offen offset:0 sc1 lds
    buffer_load_dwordx4 v4, s[16:19], s62 offen offset:1024 sc1 lds
    buffer_load_dwordx4 v4, s[16:19], s62 offen offset:2048 sc1 lds
    buffer_load_dwordx4 v4, s[16:19], s62 offen offset:3072 sc1 lds
    s_add_u32 s62, s62, 8192
    s_mov_b32 m0, 114688
    s_nop 0
    buffer_load_dwordx4 v3, s[16:19], s62 offen offset:0 sc1 lds
    buffer_load_dwordx4 v3, s[16:19], s62 offen offset:1024 sc1 lds
    buffer_load_dwordx4 v3, s[16:19], s62 offen offset:2048 sc1 lds
    buffer_load_dwordx4 v3, s[16:19], s62 offen offset:3072 sc1 lds
    s_mov_b32 m0, 118784
    s_nop 0
    buffer_load_dwordx4 v4, s[16:19], s62 offen offset:0 sc1 lds
    buffer_load_dwordx4 v4, s[16:19], s62 offen offset:1024 sc1 lds
    buffer_load_dwordx4 v4, s[16:19], s62 offen offset:2048 sc1 lds
    buffer_load_dwordx4 v4, s[16:19], s62 offen offset:3072 sc1 lds
    s_add_u32 s62, s62, 8192
    v_mov_b32 v5, 159744
    v_mov_b32 v6, 256
    s_waitcnt lgkmcnt(0)
    s_mov_b64 exec, 1
    ds_add_u32 v5, v6
    s_mov_b64 exec, -1
B_P1:
    s_waitcnt vmcnt(0) lgkmcnt(0)
B_NP:
    v_add_u32 v5, s46, v7
    v_add_u32 v4, s47, v252
    v_xor_b32 v9, 1024, v4
    v_add_u32 v6, s47, v8
    s_barrier
    ds_read_b64 v[124:125], v253 offset:0
    ds_read_b64 v[136:137], v10 offset:0
    ds_read_b64 v[126:127], v253 offset:32
    ds_read_b64 v[138:139], v10 offset:32
    ds_read_b64 v[128:129], v152 offset:64
    ds_read_b64 v[140:141], v153 offset:64
    ds_read_b64 v[130:131], v253 offset:80
    ds_read_b64 v[142:143], v10 offset:80
    ds_read_b64 v[132:133], v253 offset:112
    ds_read_b64 v[144:145], v10 offset:112
    ds_read_b128 v[68:71], v4 offset:0
    ds_read_b128 v[76:79], v5 offset:0
    ds_read_b128 v[72:75], v9 offset:0
    ds_read_b128 v[80:83], v5 offset:1024
    ds_read_b128 v[84:87], v5 offset:2048
    ds_read_b128 v[88:91], v5 offset:3072
    ds_read_b128 v[92:95], v5 offset:4096
    s_waitcnt lgkmcnt(15)
    v_lshlrev_b32 v28, 16, v124
    v_lshlrev_b32 v10, 16, v136
    v_and_b32 v29, s69, v124
    v_and_b32 v152, s69, v136
    v_add_f32 v28, v28, v10
    v_add_f32 v29, v29, v152
    v_lshlrev_b32 v30, 16, v125
    v_lshlrev_b32 v10, 16, v137
    v_and_b32 v31, s69, v125
    v_and_b32 v152, s69, v137
    v_add_f32 v30, v30, v10
    v_add_f32 v31, v31, v152
    s_waitcnt lgkmcnt(14)
    v_lshlrev_b32 v36, 16, v126
    s_waitcnt lgkmcnt(13)
    v_lshlrev_b32 v10, 16, v138
    v_and_b32 v37, s69, v126
    v_and_b32 v152, s69, v138
    v_add_f32 v36, v36, v10
    v_add_f32 v37, v37, v152
    v_lshlrev_b32 v38, 16, v127
    v_lshlrev_b32 v10, 16, v139
    v_and_b32 v39, s69, v127
    v_and_b32 v152, s69, v139
    v_add_f32 v38, v38, v10
    v_add_f32 v39, v39, v152
    s_waitcnt lgkmcnt(12)
    v_lshlrev_b32 v44, 16, v128
    s_waitcnt lgkmcnt(11)
    v_lshlrev_b32 v10, 16, v140
    v_and_b32 v45, s69, v128
    v_and_b32 v152, s69, v140
    v_add_f32 v44, v44, v10
    v_add_f32 v45, v45, v152
    v_lshlrev_b32 v46, 16, v129
    v_lshlrev_b32 v10, 16, v141
    v_and_b32 v47, s69, v129
    v_and_b32 v152, s69, v141
    v_add_f32 v46, v46, v10
    v_add_f32 v47, v47, v152
    s_waitcnt lgkmcnt(10)
    v_lshlrev_b32 v52, 16, v130
    s_waitcnt lgkmcnt(9)
    v_lshlrev_b32 v10, 16, v142
    v_and_b32 v53, s69, v130
    v_and_b32 v152, s69, v142
    v_add_f32 v52, v52, v10
    v_add_f32 v53, v53, v152
    v_lshlrev_b32 v54, 16, v131
    v_lshlrev_b32 v10, 16, v143
    v_and_b32 v55, s69, v131
    v_and_b32 v152, s69, v143
    v_add_f32 v54, v54, v10
    v_add_f32 v55, v55, v152
    s_waitcnt lgkmcnt(8)
    v_lshlrev_b32 v60, 16, v132
    s_waitcnt lgkmcnt(7)
    v_lshlrev_b32 v10, 16, v144
    v_and_b32 v61, s69, v132
    v_and_b32 v152, s69, v144
    v_add_f32 v60, v60, v10
    v_add_f32 v61, v61, v152
    v_lshlrev_b32 v62, 16, v133
    v_lshlrev_b32 v10, 16, v145
    v_and_b32 v63, s69, v133
    v_and_b32 v152, s69, v145
    v_add_f32 v62, v62, v10
    v_add_f32 v63, v63, v152
    s_mov_b32 s48, 3
B_C0:
    s_waitcnt lgkmcnt(0)
    s_barrier
    v_mfma_f32_16x16x32_bf16 v[28:31], v[76:79], v[68:71], v[28:31]
    ds_read_b128 v[96:99], v4 offset:8192
    s_add_u32 s46, s46, 20480
    v_mfma_f32_16x16x32_bf16 v[32:35], v[76:79], v[72:75], v[32:35]
    ds_read_b128 v[104:107], v5 offset:10240
    s_cmp_eq_u32 s46, 81920
    s_cselect_b32 s46, 0, s46
    v_mfma_f32_16x16x32_bf16 v[36:39], v[80:83], v[68:71], v[36:39]
    ds_read_b128 v[100:103], v9 offset:8192
    s_add_u32 s47, s47, 24576
    v_mfma_f32_16x16x32_bf16 v[40:43], v[80:83], v[72:75], v[40:43]
    ds_read_b128 v[108:111], v5 offset:11264
    s_cmp_eq_u32 s47, 73728
    s_cselect_b32 s47, 0, s47
    v_mfma_f32_16x16x32_bf16 v[44:47], v[84:87], v[68:71], v[44:47]
    ds_read_b128 v[112:115], v5 offset:12288
    v_mfma_f32_16x16x32_bf16 v[48:51], v[84:87], v[72:75], v[48:51]
    ds_read_b128 v[116:119], v5 offset:13312
    v_mfma_f32_16x16x32_bf16 v[52:55], v[88:91], v[68:71], v[52:55]
    ds_read_b128 v[120:123], v5 offset:14336
    v_mfma_f32_16x16x32_bf16 v[56:59], v[88:91], v[72:75], v[56:59]
    v_add_u32 v5, s46, v7
    v_add_u32 v4, s47, v252
    v_mfma_f32_16x16x32_bf16 v[60:63], v[92:95], v[68:71], v[60:63]
    v_xor_b32 v9, 1024, v4
    v_add_u32 v6, s47, v8
    v_mfma_f32_16x16x32_bf16 v[64:67], v[92:95], v[72:75], v[64:67]
    s_sub_u32 s48, s48, 1
    s_waitcnt lgkmcnt(0)
    s_barrier
    s_cmp_lg_u32 s48, 0
    v_mfma_f32_16x16x32_bf16 v[28:31], v[104:107], v[96:99], v[28:31]
    ds_read_b128 v[68:71], v4 offset:0
    v_mfma_f32_16x16x32_bf16 v[32:35], v[104:107], v[100:103], v[32:35]
    ds_read_b128 v[76:79], v5 offset:0
    v_mfma_f32_16x16x32_bf16 v[36:39], v[108:111], v[96:99], v[36:39]
    ds_read_b128 v[72:75], v9 offset:0
    v_mfma_f32_16x16x32_bf16 v[40:43], v[108:111], v[100:103], v[40:43]
    ds_read_b128 v[80:83], v5 offset:1024
    v_mfma_f32_16x16x32_bf16 v[44:47], v[112:115], v[96:99], v[44:47]
    ds_read_b128 v[84:87], v5 offset:2048
    v_mfma_f32_16x16x32_bf16 v[48:51], v[112:115], v[100:103], v[48:51]
    ds_read_b128 v[88:91], v5 offset:3072
    v_mfma_f32_16x16x32_bf16 v[52:55], v[116:119], v[96:99], v[52:55]
    ds_read_b128 v[92:95], v5 offset:4096
    v_mfma_f32_16x16x32_bf16 v[56:59], v[116:119], v[100:103], v[56:59]
    v_mfma_f32_16x16x32_bf16 v[60:63], v[120:123], v[96:99], v[60:63]
    v_mfma_f32_16x16x32_bf16 v[64:67], v[120:123], v[100:103], v[64:67]
    s_cbranch_scc1 B_C0
    s_add_u32 s46, s46, 20480
    s_cmp_eq_u32 s46, 81920
    s_cselect_b32 s46, 0, s46
    s_add_u32 s47, s47, 24576
    s_cmp_eq_u32 s47, 73728
    s_cselect_b32 s47, 0, s47
    v_add_u32 v5, s46, v7
    v_add_u32 v4, s47, v252
    v_xor_b32 v9, 1024, v4
    v_add_u32 v6, s47, v8
    s_waitcnt lgkmcnt(5)
    v_mfma_f32_16x16x32_bf16 v[28:31], v[76:79], v[68:71], v[28:31]
    s_waitcnt lgkmcnt(4)
    v_mfma_f32_16x16x32_bf16 v[32:35], v[76:79], v[72:75], v[32:35]
    s_waitcnt lgkmcnt(3)
    v_mfma_f32_16x16x32_bf16 v[36:39], v[80:83], v[68:71], v[36:39]
    v_mfma_f32_16x16x32_bf16 v[40:43], v[80:83], v[72:75], v[40:43]
    s_waitcnt lgkmcnt(2)
    v_mfma_f32_16x16x32_bf16 v[44:47], v[84:87], v[68:71], v[44:47]
    v_mfma_f32_16x16x32_bf16 v[48:51], v[84:87], v[72:75], v[48:51]
    s_waitcnt lgkmcnt(1)
    v_mfma_f32_16x16x32_bf16 v[52:55], v[88:91], v[68:71], v[52:55]
    v_mfma_f32_16x16x32_bf16 v[56:59], v[88:91], v[72:75], v[56:59]
    s_waitcnt lgkmcnt(0)
    v_mfma_f32_16x16x32_bf16 v[60:63], v[92:95], v[68:71], v[60:63]
    v_mfma_f32_16x16x32_bf16 v[64:67], v[92:95], v[72:75], v[64:67]
    s_mov_b32 s48, 5
    s_waitcnt lgkmcnt(0)
    s_barrier
    ds_read_b64_tr_b16 v[128:129], v6 offset:8
    ds_read_b64_tr_b16 v[130:131], v6 offset:520
    ds_read_b64_tr_b16 v[124:125], v6 offset:0
    ds_read_b64_tr_b16 v[126:127], v6 offset:512
    ds_read_b128 v[68:71], v4 offset:0
    ds_read_b128 v[76:79], v5 offset:0
    ds_read_b128 v[72:75], v9 offset:0
    ds_read_b128 v[80:83], v5 offset:1024
    ds_read_b128 v[84:87], v5 offset:2048
    ds_read_b128 v[88:91], v5 offset:3072
    ds_read_b128 v[92:95], v5 offset:4096
    v_fma_f32 v172, v244, v164, -v172
    v_fma_f32 v173, v244, v165, -v173
    v_fma_f32 v174, v244, v166, -v174
    v_fma_f32 v175, v244, v167, -v175
    v_fma_f32 v176, v244, v168, -v176
    v_fma_f32 v177, v244, v169, -v177
    v_fma_f32 v178, v244, v170, -v178
    v_fma_f32 v179, v244, v171, -v179
    v_fma_f32 v188, v245, v180, -v188
    v_fma_f32 v189, v245, v181, -v189
    v_fma_f32 v190, v245, v182, -v190
    v_fma_f32 v191, v245, v183, -v191
    s_waitcnt lgkmcnt(10)
    v_xor_b32 v132, s70, v128
    v_xor_b32 v133, s70, v129
    s_waitcnt lgkmcnt(9)
    v_xor_b32 v134, s70, v130
    v_xor_b32 v135, s70, v131
B_CL:
    s_waitcnt lgkmcnt(0)
    s_barrier
    v_mfma_f32_16x16x32_bf16 v[136:139], v[124:127], v[12:15], 0
    ds_read_b128 v[96:99], v4 offset:8192
    v_fma_f32 v192, v245, v184, -v192
    v_mfma_f32_16x16x32_bf16 v[140:143], v[128:131], v[12:15], 0
    ds_read_b128 v[104:107], v5 offset:10240
    v_fma_f32 v193, v245, v185, -v193
    v_mfma_f32_16x16x32_bf16 v[140:143], v[124:127], v[16:19], v[140:143]
    ds_read_b128 v[100:103], v9 offset:8192
    v_fma_f32 v194, v245, v186, -v194
    v_mfma_f32_16x16x32_bf16 v[136:139], v[132:135], v[16:19], v[136:139]
    ds_read_b128 v[108:111], v5 offset:11264
    v_fma_f32 v195, v245, v187, -v195
    v_mfma_f32_16x16x32_bf16 v[144:147], v[124:127], v[20:23], 0
    ds_read_b128 v[112:115], v5 offset:12288
    v_fma_f32 v204, v246, v196, -v204
    v_mfma_f32_16x16x32_bf16 v[148:151], v[128:131], v[20:23], 0
    ds_read_b128 v[116:119], v5 offset:13312
    v_fma_f32 v205, v246, v197, -v205
    v_mfma_f32_16x16x32_bf16 v[148:151], v[124:127], v[24:27], v[148:151]
    ds_read_b128 v[120:123], v5 offset:14336
    v_fma_f32 v206, v246, v198, -v206
    v_mfma_f32_16x16x32_bf16 v[144:147], v[132:135], v[24:27], v[144:147]
    v_fma_f32 v207, v246, v199, -v207
    v_mfma_f32_16x16x32_bf16 v[28:31], v[76:79], v[68:71], v[28:31]
    v_fma_f32 v208, v246, v200, -v208
    v_fma_f32 v209, v246, v201, -v209
    v_mfma_f32_16x16x32_bf16 v[32:35], v[76:79], v[72:75], v[32:35]
    v_fma_f32 v210, v246, v202, -v210
    v_fma_f32 v211, v246, v203, -v211
    v_mfma_f32_16x16x32_bf16 v[36:39], v[80:83], v[68:71], v[36:39]
    s_add_u32 s46, s46, 20480
    s_cmp_eq_u32 s46, 81920
    s_cselect_b32 s46, 0, s46
    v_mfma_f32_16x16x32_bf16 v[40:43], v[80:83], v[72:75], v[40:43]
    s_add_u32 s47, s47, 24576
    s_cmp_eq_u32 s47, 73728
    s_cselect_b32 s47, 0, s47
    v_mfma_f32_16x16x32_bf16 v[44:47], v[84:87], v[68:71], v[44:47]
    v_add_u32 v5, s46, v7
    v_add_u32 v4, s47, v252
    v_mfma_f32_16x16x32_bf16 v[48:51], v[84:87], v[72:75], v[48:51]
    v_xor_b32 v9, 1024, v4
    v_add_u32 v6, s47, v8
    v_mfma_f32_16x16x32_bf16 v[52:55], v[88:91], v[68:71], v[52:55]
    v_cvt_pk_bf16_f32 v136, v136, v140
    v_cvt_pk_bf16_f32 v137, v137, v141
    v_mfma_f32_16x16x32_bf16 v[56:59], v[88:91], v[72:75], v[56:59]
    v_cvt_pk_bf16_f32 v138, v138, v142
    v_cvt_pk_bf16_f32 v139, v139, v143
    v_mfma_f32_16x16x32_bf16 v[60:63], v[92:95], v[68:71], v[60:63]
    v_cvt_pk_bf16_f32 v144, v144, v148
    v_cvt_pk_bf16_f32 v145, v145, v149
    v_mfma_f32_16x16x32_bf16 v[64:67], v[92:95], v[72:75], v[64:67]
    v_cvt_pk_bf16_f32 v146, v146, v150
    v_cvt_pk_bf16_f32 v147, v147, v151
    s_waitcnt lgkmcnt(0)
    s_barrier
    v_mfma_f32_16x16x32_bf16 v[28:31], v[104:107], v[96:99], v[28:31]
    ds_read_b64_tr_b16 v[128:129], v6 offset:8
    ds_read_b64_tr_b16 v[130:131], v6 offset:520
    v_cvt_pk_bf16_f32 v152, v172, v176
    v_mfma_f32_16x16x32_bf16 v[32:35], v[104:107], v[100:103], v[32:35]
    ds_read_b64_tr_b16 v[124:125], v6 offset:0
    v_cvt_pk_bf16_f32 v153, v173, v177
    v_mfma_f32_16x16x32_bf16 v[36:39], v[108:111], v[96:99], v[36:39]
    ds_read_b64_tr_b16 v[126:127], v6 offset:512
    v_cvt_pk_bf16_f32 v154, v174, v178
    v_mfma_f32_16x16x32_bf16 v[40:43], v[108:111], v[100:103], v[40:43]
    ds_read_b128 v[68:71], v4 offset:0
    v_cvt_pk_bf16_f32 v155, v175, v179
    v_mfma_f32_16x16x32_bf16 v[44:47], v[112:115], v[96:99], v[44:47]
    ds_read_b128 v[76:79], v5 offset:0
    v_cvt_pk_bf16_f32 v156, v188, v192
    v_mfma_f32_16x16x32_bf16 v[48:51], v[112:115], v[100:103], v[48:51]
    ds_read_b128 v[72:75], v9 offset:0
    v_cvt_pk_bf16_f32 v157, v189, v193
    v_mfma_f32_16x16x32_bf16 v[52:55], v[116:119], v[96:99], v[52:55]
    ds_read_b128 v[80:83], v5 offset:1024
    v_cvt_pk_bf16_f32 v158, v190, v194
    v_mfma_f32_16x16x32_bf16 v[56:59], v[116:119], v[100:103], v[56:59]
    ds_read_b128 v[84:87], v5 offset:2048
    v_cvt_pk_bf16_f32 v159, v191, v195
    v_mfma_f32_16x16x32_bf16 v[60:63], v[120:123], v[96:99], v[60:63]
    ds_read_b128 v[88:91], v5 offset:3072
    v_mfma_f32_16x16x32_bf16 v[64:67], v[120:123], v[100:103], v[64:67]
    ds_read_b128 v[92:95], v5 offset:4096
    v_mfma_f32_16x16x32_bf16 v[212:215], v[152:155], v[136:139], v[212:215]
    v_cvt_pk_bf16_f32 v160, v204, v208
    v_cvt_pk_bf16_f32 v161, v205, v209
    v_mfma_f32_16x16x32_bf16 v[216:219], v[152:155], v[144:147], v[216:219]
    v_cvt_pk_bf16_f32 v162, v206, v210
    v_cvt_pk_bf16_f32 v163, v207, v211
    v_mfma_f32_16x16x32_bf16 v[220:223], v[156:159], v[136:139], v[220:223]
    v_fma_f32 v164, v244, v172, -v164
    v_fma_f32 v165, v244, v173, -v165
    v_fma_f32 v166, v244, v174, -v166
    v_fma_f32 v167, v244, v175, -v167
    v_mfma_f32_16x16x32_bf16 v[224:227], v[156:159], v[144:147], v[224:227]
    v_fma_f32 v168, v244, v176, -v168
    v_fma_f32 v169, v244, v177, -v169
    v_fma_f32 v170, v244, v178, -v170
    v_fma_f32 v171, v244, v179, -v171
    v_mfma_f32_16x16x32_bf16 v[44:47], v[160:163], v[136:139], v[44:47]
    v_fma_f32 v180, v245, v188, -v180
    v_fma_f32 v181, v245, v189, -v181
    v_fma_f32 v182, v245, v190, -v182
    v_fma_f32 v183, v245, v191, -v183
    v_mfma_f32_16x16x32_bf16 v[48:51], v[160:163], v[144:147], v[48:51]
    s_waitcnt lgkmcnt(10)
    v_xor_b32 v132, s70, v128
    v_xor_b32 v133, s70, v129
    s_waitcnt lgkmcnt(9)
    v_xor_b32 v134, s70, v130
    v_xor_b32 v135, s70, v131
    s_waitcnt lgkmcnt(0)
    s_barrier
    v_mfma_f32_16x16x32_bf16 v[136:139], v[124:127], v[12:15], 0
    ds_read_b128 v[96:99], v4 offset:8192
    v_fma_f32 v184, v245, v192, -v184
    v_mfma_f32_16x16x32_bf16 v[140:143], v[128:131], v[12:15], 0
    ds_read_b128 v[104:107], v5 offset:10240
    v_fma_f32 v185, v245, v193, -v185
    v_mfma_f32_16x16x32_bf16 v[140:143], v[124:127], v[16:19], v[140:143]
    ds_read_b128 v[100:103], v9 offset:8192
    v_fma_f32 v186, v245, v194, -v186
    v_mfma_f32_16x16x32_bf16 v[136:139], v[132:135], v[16:19], v[136:139]
    ds_read_b128 v[108:111], v5 offset:11264
    v_fma_f32 v187, v245, v195, -v187
    v_mfma_f32_16x16x32_bf16 v[144:147], v[124:127], v[20:23], 0
    ds_read_b128 v[112:115], v5 offset:12288
    v_fma_f32 v196, v246, v204, -v196
    v_mfma_f32_16x16x32_bf16 v[148:151], v[128:131], v[20:23], 0
    ds_read_b128 v[116:119], v5 offset:13312
    v_fma_f32 v197, v246, v205, -v197
    v_mfma_f32_16x16x32_bf16 v[148:151], v[124:127], v[24:27], v[148:151]
    ds_read_b128 v[120:123], v5 offset:14336
    v_fma_f32 v198, v246, v206, -v198
    v_mfma_f32_16x16x32_bf16 v[144:147], v[132:135], v[24:27], v[144:147]
    v_fma_f32 v199, v246, v207, -v199
    v_mfma_f32_16x16x32_bf16 v[28:31], v[76:79], v[68:71], v[28:31]
    v_fma_f32 v200, v246, v208, -v200
    v_fma_f32 v201, v246, v209, -v201
    v_mfma_f32_16x16x32_bf16 v[32:35], v[76:79], v[72:75], v[32:35]
    v_fma_f32 v202, v246, v210, -v202
    v_fma_f32 v203, v246, v211, -v203
    v_mfma_f32_16x16x32_bf16 v[36:39], v[80:83], v[68:71], v[36:39]
    s_add_u32 s46, s46, 20480
    s_cmp_eq_u32 s46, 81920
    s_cselect_b32 s46, 0, s46
    v_mfma_f32_16x16x32_bf16 v[40:43], v[80:83], v[72:75], v[40:43]
    s_add_u32 s47, s47, 24576
    s_cmp_eq_u32 s47, 73728
    s_cselect_b32 s47, 0, s47
    v_mfma_f32_16x16x32_bf16 v[44:47], v[84:87], v[68:71], v[44:47]
    v_add_u32 v5, s46, v7
    v_add_u32 v4, s47, v252
    v_mfma_f32_16x16x32_bf16 v[48:51], v[84:87], v[72:75], v[48:51]
    v_xor_b32 v9, 1024, v4
    v_add_u32 v6, s47, v8
    v_mfma_f32_16x16x32_bf16 v[52:55], v[88:91], v[68:71], v[52:55]
    v_cvt_pk_bf16_f32 v136, v136, v140
    v_cvt_pk_bf16_f32 v137, v137, v141
    v_mfma_f32_16x16x32_bf16 v[56:59], v[88:91], v[72:75], v[56:59]
    v_cvt_pk_bf16_f32 v138, v138, v142
    v_cvt_pk_bf16_f32 v139, v139, v143
    v_mfma_f32_16x16x32_bf16 v[60:63], v[92:95], v[68:71], v[60:63]
    v_cvt_pk_bf16_f32 v144, v144, v148
    v_cvt_pk_bf16_f32 v145, v145, v149
    v_mfma_f32_16x16x32_bf16 v[64:67], v[92:95], v[72:75], v[64:67]
    v_cvt_pk_bf16_f32 v146, v146, v150
    v_cvt_pk_bf16_f32 v147, v147, v151
    s_sub_u32 s48, s48, 1
    s_cmp_eq_u32 s48, 0
    s_cbranch_scc1 B_CE
    s_waitcnt lgkmcnt(0)
    s_barrier
    v_mfma_f32_16x16x32_bf16 v[28:31], v[104:107], v[96:99], v[28:31]
    ds_read_b64_tr_b16 v[128:129], v6 offset:8
    ds_read_b64_tr_b16 v[130:131], v6 offset:520
    v_cvt_pk_bf16_f32 v152, v164, v168
    v_mfma_f32_16x16x32_bf16 v[32:35], v[104:107], v[100:103], v[32:35]
    ds_read_b64_tr_b16 v[124:125], v6 offset:0
    v_cvt_pk_bf16_f32 v153, v165, v169
    v_mfma_f32_16x16x32_bf16 v[36:39], v[108:111], v[96:99], v[36:39]
    ds_read_b64_tr_b16 v[126:127], v6 offset:512
    v_cvt_pk_bf16_f32 v154, v166, v170
    v_mfma_f32_16x16x32_bf16 v[40:43], v[108:111], v[100:103], v[40:43]
    ds_read_b128 v[68:71], v4 offset:0
    v_cvt_pk_bf16_f32 v155, v167, v171
    v_mfma_f32_16x16x32_bf16 v[44:47], v[112:115], v[96:99], v[44:47]
    ds_read_b128 v[76:79], v5 offset:0
    v_cvt_pk_bf16_f32 v156, v180, v184
    v_mfma_f32_16x16x32_bf16 v[48:51], v[112:115], v[100:103], v[48:51]
    ds_read_b128 v[72:75], v9 offset:0
    v_cvt_pk_bf16_f32 v157, v181, v185
    v_mfma_f32_16x16x32_bf16 v[52:55], v[116:119], v[96:99], v[52:55]
    ds_read_b128 v[80:83], v5 offset:1024
    v_cvt_pk_bf16_f32 v158, v182, v186
    v_mfma_f32_16x16x32_bf16 v[56:59], v[116:119], v[100:103], v[56:59]
    ds_read_b128 v[84:87], v5 offset:2048
    v_cvt_pk_bf16_f32 v159, v183, v187
    v_mfma_f32_16x16x32_bf16 v[60:63], v[120:123], v[96:99], v[60:63]
    ds_read_b128 v[88:91], v5 offset:3072
    v_mfma_f32_16x16x32_bf16 v[64:67], v[120:123], v[100:103], v[64:67]
    ds_read_b128 v[92:95], v5 offset:4096
    v_mfma_f32_16x16x32_bf16 v[212:215], v[152:155], v[136:139], v[212:215]
    v_cvt_pk_bf16_f32 v160, v196, v200
    v_cvt_pk_bf16_f32 v161, v197, v201
    v_mfma_f32_16x16x32_bf16 v[216:219], v[152:155], v[144:147], v[216:219]
    v_cvt_pk_bf16_f32 v162, v198, v202
    v_cvt_pk_bf16_f32 v163, v199, v203
    v_mfma_f32_16x16x32_bf16 v[220:223], v[156:159], v[136:139], v[220:223]
    v_fma_f32 v172, v244, v164, -v172
    v_fma_f32 v173, v244, v165, -v173
    v_fma_f32 v174, v244, v166, -v174
    v_fma_f32 v175, v244, v167, -v175
    v_mfma_f32_16x16x32_bf16 v[224:227], v[156:159], v[144:147], v[224:227]
    v_fma_f32 v176, v244, v168, -v176
    v_fma_f32 v177, v244, v169, -v177
    v_fma_f32 v178, v244, v170, -v178
    v_fma_f32 v179, v244, v171, -v179
    v_mfma_f32_16x16x32_bf16 v[44:47], v[160:163], v[136:139], v[44:47]
    v_fma_f32 v188, v245, v180, -v188
    v_fma_f32 v189, v245, v181, -v189
    v_fma_f32 v190, v245, v182, -v190
    v_fma_f32 v191, v245, v183, -v191
    v_mfma_f32_16x16x32_bf16 v[48:51], v[160:163], v[144:147], v[48:51]
    s_waitcnt lgkmcnt(10)
    v_xor_b32 v132, s70, v128
    v_xor_b32 v133, s70, v129
    s_waitcnt lgkmcnt(9)
    v_xor_b32 v134, s70, v130
    v_xor_b32 v135, s70, v131
    s_branch B_CL
B_CE:
    s_waitcnt lgkmcnt(5)
    v_mfma_f32_16x16x32_bf16 v[28:31], v[104:107], v[96:99], v[28:31]
    v_cvt_pk_bf16_f32 v152, v164, v168
    v_cvt_pk_bf16_f32 v153, v165, v169
    s_waitcnt lgkmcnt(4)
    v_mfma_f32_16x16x32_bf16 v[32:35], v[104:107], v[100:103], v[32:35]
    v_cvt_pk_bf16_f32 v154, v166, v170
    v_cvt_pk_bf16_f32 v155, v167, v171
    s_waitcnt lgkmcnt(3)
    v_mfma_f32_16x16x32_bf16 v[36:39], v[108:111], v[96:99], v[36:39]
    v_cvt_pk_bf16_f32 v156, v180, v184
    v_cvt_pk_bf16_f32 v157, v181, v185
    v_mfma_f32_16x16x32_bf16 v[40:43], v[108:111], v[100:103], v[40:43]
    v_cvt_pk_bf16_f32 v158, v182, v186
    v_cvt_pk_bf16_f32 v159, v183, v187
    s_waitcnt lgkmcnt(2)
    v_mfma_f32_16x16x32_bf16 v[44:47], v[112:115], v[96:99], v[44:47]
    v_mfma_f32_16x16x32_bf16 v[48:51], v[112:115], v[100:103], v[48:51]
    s_waitcnt lgkmcnt(1)
    v_mfma_f32_16x16x32_bf16 v[52:55], v[116:119], v[96:99], v[52:55]
    v_mfma_f32_16x16x32_bf16 v[56:59], v[116:119], v[100:103], v[56:59]
    s_waitcnt lgkmcnt(0)
    v_mfma_f32_16x16x32_bf16 v[60:63], v[120:123], v[96:99], v[60:63]
    v_mfma_f32_16x16x32_bf16 v[64:67], v[120:123], v[100:103], v[64:67]
    v_mfma_f32_16x16x32_bf16 v[212:215], v[152:155], v[136:139], v[212:215]
    v_cvt_pk_bf16_f32 v160, v196, v200
    v_cvt_pk_bf16_f32 v161, v197, v201
    v_mfma_f32_16x16x32_bf16 v[216:219], v[152:155], v[144:147], v[216:219]
    v_cvt_pk_bf16_f32 v162, v198, v202
    v_cvt_pk_bf16_f32 v163, v199, v203
    v_mfma_f32_16x16x32_bf16 v[220:223], v[156:159], v[136:139], v[220:223]
    s_xor_b32 s50, s32, 2
    s_mul_i32 s50, s50, 5120
    v_mfma_f32_16x16x32_bf16 v[224:227], v[156:159], v[144:147], v[224:227]
    v_add_u32 v9, s50, v3
    s_mul_i32 s50, s32, 5120
    v_mfma_f32_16x16x32_bf16 v[44:47], v[160:163], v[136:139], v[44:47]
    v_add_u32 v10, s50, v3
    v_add_u32 v11, s50, v11
    v_mfma_f32_16x16x32_bf16 v[48:51], v[160:163], v[144:147], v[48:51]
    s_cmp_eq_u32 s45, 0
    s_cselect_b32 s50, -1.0, 1.0
    v_mov_b32 v152, s50
    v_mov_b32 v153, s50
    v_add_u32 v154, v11, v254
    v_pk_add_f32 v[32:33], v[32:33], v[216:217]
    v_pk_fma_f32 v[56:57], v[216:217], v[152:153], v[56:57]
    v_pk_add_f32 v[34:35], v[34:35], v[218:219]
    v_pk_fma_f32 v[58:59], v[218:219], v[152:153], v[58:59]
    v_pk_add_f32 v[40:41], v[40:41], v[224:225]
    v_pk_fma_f32 v[64:65], v[224:225], v[152:153], v[64:65]
    v_pk_add_f32 v[42:43], v[42:43], v[226:227]
    v_pk_fma_f32 v[66:67], v[226:227], v[152:153], v[66:67]
    ds_write_b128 v9, v[32:35] offset:40960
    ds_write_b128 v9, v[56:59] offset:44032
    ds_write_b128 v9, v[40:43] offset:41984
    ds_write_b128 v9, v[64:67] offset:45056
    ds_write_b128 v9, v[48:51] offset:43008
    v_pk_add_f32 v[28:29], v[28:29], v[212:213]
    v_pk_fma_f32 v[52:53], v[212:213], v[152:153], v[52:53]
    v_pk_add_f32 v[30:31], v[30:31], v[214:215]
    v_pk_fma_f32 v[54:55], v[214:215], v[152:153], v[54:55]
    v_pk_add_f32 v[36:37], v[36:37], v[220:221]
    v_pk_fma_f32 v[60:61], v[220:221], v[152:153], v[60:61]
    v_pk_add_f32 v[38:39], v[38:39], v[222:223]
    v_pk_fma_f32 v[62:63], v[222:223], v[152:153], v[62:63]
    s_waitcnt lgkmcnt(0)
    s_barrier
    ds_read_b128 v[68:71], v10 offset:40960
    ds_read_b128 v[72:75], v10 offset:41984
    ds_read_b128 v[76:79], v10 offset:43008
    ds_read_b128 v[80:83], v10 offset:44032
    ds_read_b128 v[84:87], v10 offset:45056
    s_waitcnt lgkmcnt(4)
    v_pk_add_f32 v[28:29], v[28:29], v[68:69]
    v_pk_add_f32 v[30:31], v[30:31], v[70:71]
    v_cvt_pk_bf16_f32 v32, v28, v29
    v_cvt_pk_bf16_f32 v33, v30, v31
    ds_write_b64 v11, v[32:33] offset:61440
    s_waitcnt lgkmcnt(4)
    v_pk_add_f32 v[36:37], v[36:37], v[72:73]
    v_pk_add_f32 v[38:39], v[38:39], v[74:75]
    v_cvt_pk_bf16_f32 v40, v36, v37
    v_cvt_pk_bf16_f32 v41, v38, v39
    ds_write_b64 v11, v[40:41] offset:61472
    s_waitcnt lgkmcnt(4)
    v_pk_add_f32 v[44:45], v[44:45], v[76:77]
    v_pk_add_f32 v[46:47], v[46:47], v[78:79]
    v_cvt_pk_bf16_f32 v48, v44, v45
    v_cvt_pk_bf16_f32 v49, v46, v47
    ds_write_b64 v154, v[48:49] offset:61504
    s_waitcnt lgkmcnt(4)
    v_pk_add_f32 v[52:53], v[52:53], v[80:81]
    v_pk_add_f32 v[54:55], v[54:55], v[82:83]
    v_cvt_pk_bf16_f32 v56, v52, v53
    v_cvt_pk_bf16_f32 v57, v54, v55
    ds_write_b64 v11, v[56:57] offset:61520
    s_waitcnt lgkmcnt(4)
    v_pk_add_f32 v[60:61], v[60:61], v[84:85]
    v_pk_add_f32 v[62:63], v[62:63], v[86:87]
    v_cvt_pk_bf16_f32 v64, v60, v61
    v_cvt_pk_bf16_f32 v65, v62, v63
    ds_write_b64 v11, v[64:65] offset:61552
    s_waitcnt lgkmcnt(0)
    ds_read_b128 v[88:91], v10 offset:61440
    ds_read_b128 v[92:95], v10 offset:62464
    ds_read_b128 v[96:99], v10 offset:63488
    s_waitcnt lgkmcnt(2)
    buffer_store_dwordx4 v[88:91], v249, s[20:23], s59 offen
    s_waitcnt lgkmcnt(1)
    buffer_store_dwordx4 v[92:95], v250, s[20:23], s59 offen
    s_mov_b32 exec_hi, 0
    s_waitcnt lgkmcnt(0)
    buffer_store_dwordx4 v[96:99], v251, s[20:23], s59 offen
    s_endpgm
B_LH:
    s_setprio 0
    s_cmp_ge_u32 s45, s47
    s_cselect_b32 s53, 1, 0
    s_lshr_b32 s42, s41, 3
    s_lshl_b32 s33, s40, 2
    s_add_u32 s33, s33, s42
    s_and_b32 s34, s41, 7
    v_lshlrev_b32 v3, 4, v0
    s_add_u32 s56, s14, 20971520
    s_addc_u32 s57, s15, 0
    s_cmp_eq_u32 s53, 1
    s_cbranch_scc1 B_LH1
    s_mov_b32 s52, 429496730
    v_add_u32 v9, 0, v0
    v_mul_hi_u32 v10, v9, s52
    v_mul_u32_u24 v11, 10, v10
    v_sub_u32 v11, v9, v11
    v_cmp_le_u32 vcc, 5, v11
    v_add_u32 v9, 35, v11
    s_nop 0
    v_cndmask_b32 v11, v11, v9, vcc
    v_mul_u32_u24 v10, 81920, v10
    v_lshl_add_u32 v12, v11, 4, v10
    v_add_u32 v9, 64, v0
    v_mul_hi_u32 v10, v9, s52
    v_mul_u32_u24 v11, 10, v10
    v_sub_u32 v11, v9, v11
    v_cmp_le_u32 vcc, 5, v11
    v_add_u32 v9, 35, v11
    s_nop 0
    v_cndmask_b32 v11, v11, v9, vcc
    v_mul_u32_u24 v10, 81920, v10
    v_lshl_add_u32 v13, v11, 4, v10
    v_add_u32 v9, 128, v0
    v_mul_hi_u32 v10, v9, s52
    v_mul_u32_u24 v11, 10, v10
    v_sub_u32 v11, v9, v11
    v_cmp_le_u32 vcc, 5, v11
    v_add_u32 v9, 35, v11
    s_nop 0
    v_cndmask_b32 v11, v11, v9, vcc
    v_mul_u32_u24 v10, 81920, v10
    v_lshl_add_u32 v14, v11, 4, v10
    s_load_dwordx2 s[10:11], s[0:1], 56
    s_mul_i32 s54, s34, 80
    s_mul_i32 s63, s33, 2560
    s_add_u32 s63, s63, s54
    s_add_u32 s65, s33, 80
    s_lshl_b32 s65, s65, 8
    s_waitcnt lgkmcnt(0)
    s_mov_b64 s[28:29], s[4:5]
    s_mov_b32 s30, 2621440
    s_mov_b32 s31, 0x20000
    s_mov_b64 s[24:25], s[10:11]
    s_mov_b32 s26, 1280
    s_mov_b32 s27, 0x20000
    s_add_u32 s64, s63, 0
    s_mov_b32 m0, 98304
    s_nop 0
    buffer_load_dwordx4 v12, s[28:31], s64 offen lds
    s_mov_b32 m0, 99328
    s_nop 0
    buffer_load_dwordx4 v13, s[28:31], s64 offen lds
    s_mov_b32 m0, 100352
    s_mov_b32 exec_hi, 0
    buffer_load_dwordx4 v14, s[28:31], s64 offen lds
    s_mov_b64 exec, -1
    s_add_u32 s64, s63, 1280
    s_mov_b32 m0, 100864
    s_nop 0
    buffer_load_dwordx4 v12, s[28:31], s64 offen lds
    s_mov_b32 m0, 101888
    s_nop 0
    buffer_load_dwordx4 v13, s[28:31], s64 offen lds
    s_mov_b32 m0, 102912
    s_mov_b32 exec_hi, 0
    buffer_load_dwordx4 v14, s[28:31], s64 offen lds
    s_mov_b64 exec, -1
    s_add_u32 s64, s63, 1310720
    s_mov_b32 m0, 103424
    s_nop 0
    buffer_load_dwordx4 v12, s[28:31], s64 offen lds
    s_mov_b32 m0, 104448
    s_nop 0
    buffer_load_dwordx4 v13, s[28:31], s64 offen lds
    s_mov_b32 m0, 105472
    s_mov_b32 exec_hi, 0
    buffer_load_dwordx4 v14, s[28:31], s64 offen lds
    s_mov_b64 exec, -1
    s_add_u32 s64, s63, 1312000
    s_mov_b32 m0, 124160
    s_nop 0
    buffer_load_dwordx4 v12, s[28:31], s64 offen lds
    s_mov_b32 m0, 125184
    s_nop 0
    buffer_load_dwordx4 v13, s[28:31], s64 offen lds
    s_mov_b32 m0, 126208
    s_mov_b32 exec_hi, 0
    buffer_load_dwordx4 v14, s[28:31], s64 offen lds
    s_mov_b64 exec, -1
    s_mov_b32 m0, 105984
    s_mov_b64 exec, 0x3ff
    buffer_load_dwordx4 v12, s[24:27], s54 offen lds
    s_mov_b64 exec, -1
    s_mul_i32 s50, s33, 221184
    s_add_u32 s50, s50, 0
    s_add_u32 s16, s14, s50
    s_addc_u32 s17, s15, 0
    s_mov_b32 s18, 221184
    s_mov_b32 s19, 0x20000
    v_mov_b32 v4, 159744
    s_mov_b32 s61, 4000000
L_28:
    ds_read_b32 v5, v4
    s_waitcnt lgkmcnt(0)
    v_readfirstlane_b32 s60, v5
    s_nop 1
    s_bfe_u32 s60, s60, 524288
    s_cmp_ge_u32 s60, 4
    s_cbranch_scc1 L_29
    s_sub_u32 s61, s61, 1
    s_cmp_lg_u32 s61, 0
    s_sleep 1
    s_cbranch_scc1 L_28
L_29:
    v_add_u32 v4, 4096, v3
    s_mov_b32 s62, 0
    s_mov_b32 s61, 100000
L_30:
    s_mov_b32 s60, 0
    s_atomic_add s60, s[56:57], s65 glc
L_32:
    s_waitcnt lgkmcnt(0)
    s_bfe_u32 s60, s60, 524288
    s_cmp_eq_u32 s60, 22
    s_cbranch_scc1 L_31
    s_sub_u32 s61, s61, 1
    s_cmp_eq_u32 s61, 0
    s_cbranch_scc1 L_31
    s_sleep 2
    s_branch L_30
L_31:
    s_mov_b32 m0, 81920
    s_nop 0
    buffer_load_dwordx4 v3, s[16:19], s62 offen offset:0 sc1 lds
    buffer_load_dwordx4 v3, s[16:19], s62 offen offset:1024 sc1 lds
    buffer_load_dwordx4 v3, s[16:19], s62 offen offset:2048 sc1 lds
    buffer_load_dwordx4 v3, s[16:19], s62 offen offset:3072 sc1 lds
    s_mov_b32 m0, 86016
    s_nop 0
    buffer_load_dwordx4 v4, s[16:19], s62 offen offset:0 sc1 lds
    buffer_load_dwordx4 v4, s[16:19], s62 offen offset:1024 sc1 lds
    buffer_load_dwordx4 v4, s[16:19], s62 offen offset:2048 sc1 lds
    buffer_load_dwordx4 v4, s[16:19], s62 offen offset:3072 sc1 lds
    s_add_u32 s62, s62, 8192
    s_mov_b32 m0, 90112
    s_nop 0
    buffer_load_dwordx4 v3, s[16:19], s62 offen offset:0 sc1 lds
    buffer_load_dwordx4 v3, s[16:19], s62 offen offset:1024 sc1 lds
    buffer_load_dwordx4 v3, s[16:19], s62 offen offset:2048 sc1 lds
    buffer_load_dwordx4 v3, s[16:19], s62 offen offset:3072 sc1 lds
    s_mov_b32 m0, 94208
    s_nop 0
    buffer_load_dwordx4 v4, s[16:19], s62 offen offset:0 sc1 lds
    buffer_load_dwordx4 v4, s[16:19], s62 offen offset:1024 sc1 lds
    buffer_load_dwordx4 v4, s[16:19], s62 offen offset:2048 sc1 lds
    buffer_load_dwordx4 v4, s[16:19], s62 offen offset:3072 sc1 lds
    s_add_u32 s62, s62, 8192
    s_mov_b32 m0, 106496
    s_nop 0
    buffer_load_dwordx4 v3, s[16:19], s62 offen offset:0 sc1 lds
    buffer_load_dwordx4 v3, s[16:19], s62 offen offset:1024 sc1 lds
    buffer_load_dwordx4 v3, s[16:19], s62 offen offset:2048 sc1 lds
    buffer_load_dwordx4 v3, s[16:19], s62 offen offset:3072 sc1 lds
    s_mov_b32 m0, 110592
    s_nop 0
    buffer_load_dwordx4 v4, s[16:19], s62 offen offset:0 sc1 lds
    buffer_load_dwordx4 v4, s[16:19], s62 offen offset:1024 sc1 lds
    buffer_load_dwordx4 v4, s[16:19], s62 offen offset:2048 sc1 lds
    buffer_load_dwordx4 v4, s[16:19], s62 offen offset:3072 sc1 lds
    s_add_u32 s62, s62, 8192
    s_mov_b32 m0, 114688
    s_nop 0
    buffer_load_dwordx4 v3, s[16:19], s62 offen offset:0 sc1 lds
    buffer_load_dwordx4 v3, s[16:19], s62 offen offset:1024 sc1 lds
    buffer_load_dwordx4 v3, s[16:19], s62 offen offset:2048 sc1 lds
    buffer_load_dwordx4 v3, s[16:19], s62 offen offset:3072 sc1 lds
    s_mov_b32 m0, 118784
    s_nop 0
    buffer_load_dwordx4 v4, s[16:19], s62 offen offset:0 sc1 lds
    buffer_load_dwordx4 v4, s[16:19], s62 offen offset:1024 sc1 lds
    buffer_load_dwordx4 v4, s[16:19], s62 offen offset:2048 sc1 lds
    buffer_load_dwordx4 v4, s[16:19], s62 offen offset:3072 sc1 lds
    s_add_u32 s62, s62, 8192
    v_mov_b32 v5, 159744
    v_mov_b32 v6, 256
    s_waitcnt lgkmcnt(0)
    s_mov_b64 exec, 1
    ds_add_u32 v5, v6
    s_mov_b64 exec, -1
B_LH1:
    s_add_u32 s65, s33, 80
    s_lshl_b32 s65, s65, 8
    v_add_u32 v4, 4096, v3
    v_and_b32 v6, 16, v0
    v_lshlrev_b32 v6, 2, v6
    v_xor_b32 v6, v6, v3
    v_add_u32 v7, 4096, v6
    s_mov_b32 s62, 32768
    s_mov_b32 s63, 0
    s_mul_i32 s50, s33, 221184
    s_add_u32 s50, s50, 0
    s_add_u32 s16, s14, s50
    s_addc_u32 s17, s15, 0
    s_mov_b32 s18, 221184
    s_mov_b32 s19, 0x20000
    s_mul_i32 s50, s33, 81920
    s_add_u32 s50, s50, 16777216
    s_add_u32 s24, s14, s50
    s_addc_u32 s25, s15, 0
    s_mov_b32 s26, 81920
    s_mov_b32 s27, 0x20000
    s_waitcnt vmcnt(24)
    s_barrier
    s_setprio 3
    s_mov_b32 m0, 131072
    s_nop 0
    buffer_load_dwordx4 v3, s[16:19], s62 offen offset:0 sc1 lds
    buffer_load_dwordx4 v3, s[16:19], s62 offen offset:1024 sc1 lds
    buffer_load_dwordx4 v3, s[16:19], s62 offen offset:2048 sc1 lds
    buffer_load_dwordx4 v3, s[16:19], s62 offen offset:3072 sc1 lds
    s_mov_b32 m0, 135168
    s_nop 0
    buffer_load_dwordx4 v4, s[16:19], s62 offen offset:0 sc1 lds
    buffer_load_dwordx4 v4, s[16:19], s62 offen offset:1024 sc1 lds
    buffer_load_dwordx4 v4, s[16:19], s62 offen offset:2048 sc1 lds
    buffer_load_dwordx4 v4, s[16:19], s62 offen offset:3072 sc1 lds
    s_add_u32 s62, s62, 8192
    s_waitcnt vmcnt(24)
    s_barrier
    s_mov_b32 m0, 139264
    s_nop 0
    buffer_load_dwordx4 v3, s[16:19], s62 offen offset:0 sc1 lds
    buffer_load_dwordx4 v3, s[16:19], s62 offen offset:1024 sc1 lds
    buffer_load_dwordx4 v3, s[16:19], s62 offen offset:2048 sc1 lds
    buffer_load_dwordx4 v3, s[16:19], s62 offen offset:3072 sc1 lds
    s_mov_b32 m0, 143360
    s_nop 0
    buffer_load_dwordx4 v4, s[16:19], s62 offen offset:0 sc1 lds
    buffer_load_dwordx4 v4, s[16:19], s62 offen offset:1024 sc1 lds
    buffer_load_dwordx4 v4, s[16:19], s62 offen offset:2048 sc1 lds
    buffer_load_dwordx4 v4, s[16:19], s62 offen offset:3072 sc1 lds
    s_add_u32 s62, s62, 8192
    s_waitcnt vmcnt(24)
    s_barrier
    s_mov_b32 m0, 81920
    s_nop 0
    buffer_load_dwordx4 v3, s[16:19], s62 offen offset:0 sc1 lds
    buffer_load_dwordx4 v3, s[16:19], s62 offen offset:1024 sc1 lds
    buffer_load_dwordx4 v3, s[16:19], s62 offen offset:2048 sc1 lds
    buffer_load_dwordx4 v3, s[16:19], s62 offen offset:3072 sc1 lds
    s_mov_b32 m0, 86016
    s_nop 0
    buffer_load_dwordx4 v4, s[16:19], s62 offen offset:0 sc1 lds
    buffer_load_dwordx4 v4, s[16:19], s62 offen offset:1024 sc1 lds
    buffer_load_dwordx4 v4, s[16:19], s62 offen offset:2048 sc1 lds
    buffer_load_dwordx4 v4, s[16:19], s62 offen offset:3072 sc1 lds
    s_add_u32 s62, s62, 8192
    s_waitcnt vmcnt(24)
    s_barrier
    s_mov_b32 m0, 106496
    s_nop 0
    buffer_load_dwordx4 v3, s[16:19], s62 offen offset:0 sc1 lds
    buffer_load_dwordx4 v3, s[16:19], s62 offen offset:1024 sc1 lds
    buffer_load_dwordx4 v3, s[16:19], s62 offen offset:2048 sc1 lds
    buffer_load_dwordx4 v3, s[16:19], s62 offen offset:3072 sc1 lds
    s_mov_b32 m0, 110592
    s_nop 0
    buffer_load_dwordx4 v4, s[16:19], s62 offen offset:0 sc1 lds
    buffer_load_dwordx4 v4, s[16:19], s62 offen offset:1024 sc1 lds
    buffer_load_dwordx4 v4, s[16:19], s62 offen offset:2048 sc1 lds
    buffer_load_dwordx4 v4, s[16:19], s62 offen offset:3072 sc1 lds
    s_add_u32 s62, s62, 8192
    s_waitcnt vmcnt(24)
    s_barrier
    s_mov_b32 m0, 114688
    s_nop 0
    buffer_load_dwordx4 v3, s[16:19], s62 offen offset:0 sc1 lds
    buffer_load_dwordx4 v3, s[16:19], s62 offen offset:1024 sc1 lds
    buffer_load_dwordx4 v3, s[16:19], s62 offen offset:2048 sc1 lds
    buffer_load_dwordx4 v3, s[16:19], s62 offen offset:3072 sc1 lds
    s_mov_b32 m0, 118784
    s_nop 0
    buffer_load_dwordx4 v4, s[16:19], s62 offen offset:0 sc1 lds
    buffer_load_dwordx4 v4, s[16:19], s62 offen offset:1024 sc1 lds
    buffer_load_dwordx4 v4, s[16:19], s62 offen offset:2048 sc1 lds
    buffer_load_dwordx4 v4, s[16:19], s62 offen offset:3072 sc1 lds
    s_add_u32 s62, s62, 8192
    s_waitcnt vmcnt(24)
    s_barrier
    s_mov_b32 s61, 100000
L_33:
    s_mov_b32 s60, 0
    s_atomic_add s60, s[56:57], s65 glc
L_35:
    s_waitcnt lgkmcnt(0)
    s_bfe_u32 s60, s60, 524296
    s_cmp_eq_u32 s60, 20
    s_cbranch_scc1 L_34
    s_sub_u32 s61, s61, 1
    s_cmp_eq_u32 s61, 0
    s_cbranch_scc1 L_34
    s_sleep 2
    s_branch L_33
L_34:
    s_mov_b32 m0, 122880
    s_nop 0
    buffer_load_dwordx4 v6, s[24:27], s63 offen offset:0 sc1 lds
    buffer_load_dwordx4 v6, s[24:27], s63 offen offset:1024 sc1 lds
    buffer_load_dwordx4 v6, s[24:27], s63 offen offset:2048 sc1 lds
    buffer_load_dwordx4 v6, s[24:27], s63 offen offset:3072 sc1 lds
    s_mov_b32 m0, 126976
    s_nop 0
    buffer_load_dwordx4 v7, s[24:27], s63 offen offset:0 sc1 lds
    buffer_load_dwordx4 v7, s[24:27], s63 offen offset:1024 sc1 lds
    buffer_load_dwordx4 v7, s[24:27], s63 offen offset:2048 sc1 lds
    buffer_load_dwordx4 v7, s[24:27], s63 offen offset:3072 sc1 lds
    s_add_u32 s63, s63, 8192
    s_mov_b32 m0, 131072
    s_nop 0
    buffer_load_dwordx4 v3, s[16:19], s62 offen offset:0 sc1 lds
    buffer_load_dwordx4 v3, s[16:19], s62 offen offset:1024 sc1 lds
    buffer_load_dwordx4 v3, s[16:19], s62 offen offset:2048 sc1 lds
    buffer_load_dwordx4 v3, s[16:19], s62 offen offset:3072 sc1 lds
    s_mov_b32 m0, 135168
    s_nop 0
    buffer_load_dwordx4 v4, s[16:19], s62 offen offset:0 sc1 lds
    buffer_load_dwordx4 v4, s[16:19], s62 offen offset:1024 sc1 lds
    buffer_load_dwordx4 v4, s[16:19], s62 offen offset:2048 sc1 lds
    buffer_load_dwordx4 v4, s[16:19], s62 offen offset:3072 sc1 lds
    s_add_u32 s62, s62, 8192
    s_mov_b32 m0, 147456
    s_nop 0
    buffer_load_dwordx4 v6, s[24:27], s63 offen offset:0 sc1 lds
    buffer_load_dwordx4 v6, s[24:27], s63 offen offset:1024 sc1 lds
    buffer_load_dwordx4 v6, s[24:27], s63 offen offset:2048 sc1 lds
    buffer_load_dwordx4 v6, s[24:27], s63 offen offset:3072 sc1 lds
    s_mov_b32 m0, 151552
    s_nop 0
    buffer_load_dwordx4 v7, s[24:27], s63 offen offset:0 sc1 lds
    buffer_load_dwordx4 v7, s[24:27], s63 offen offset:1024 sc1 lds
    buffer_load_dwordx4 v7, s[24:27], s63 offen offset:2048 sc1 lds
    buffer_load_dwordx4 v7, s[24:27], s63 offen offset:3072 sc1 lds
    s_add_u32 s63, s63, 8192
    s_waitcnt vmcnt(40)
    s_barrier
    s_mov_b32 s64, 131072
    s_mov_b32 s48, 9
B_LL:
    s_add_u32 m0, s64, 8192
    s_nop 0
    buffer_load_dwordx4 v3, s[16:19], s62 offen offset:0 sc1 lds
    buffer_load_dwordx4 v3, s[16:19], s62 offen offset:1024 sc1 lds
    buffer_load_dwordx4 v3, s[16:19], s62 offen offset:2048 sc1 lds
    buffer_load_dwordx4 v3, s[16:19], s62 offen offset:3072 sc1 lds
    s_add_u32 m0, s64, 12288
    s_nop 0
    buffer_load_dwordx4 v4, s[16:19], s62 offen offset:0 sc1 lds
    buffer_load_dwordx4 v4, s[16:19], s62 offen offset:1024 sc1 lds
    buffer_load_dwordx4 v4, s[16:19], s62 offen offset:2048 sc1 lds
    buffer_load_dwordx4 v4, s[16:19], s62 offen offset:3072 sc1 lds
    s_add_u32 s62, s62, 8192
    s_add_u32 s64, s64, 24576
    s_cmp_eq_u32 s64, 155648
    s_cselect_b32 s64, 81920, s64
    s_sub_u32 s48, s48, 1
    s_cmp_eq_u32 s48, 0
    s_waitcnt vmcnt(24)
    s_barrier
    s_cbranch_scc1 B_LE
    s_add_u32 m0, s64, 0
    s_nop 0
    buffer_load_dwordx4 v3, s[16:19], s62 offen offset:0 sc1 lds
    buffer_load_dwordx4 v3, s[16:19], s62 offen offset:1024 sc1 lds
    buffer_load_dwordx4 v3, s[16:19], s62 offen offset:2048 sc1 lds
    buffer_load_dwordx4 v3, s[16:19], s62 offen offset:3072 sc1 lds
    s_add_u32 m0, s64, 4096
    s_nop 0
    buffer_load_dwordx4 v4, s[16:19], s62 offen offset:0 sc1 lds
    buffer_load_dwordx4 v4, s[16:19], s62 offen offset:1024 sc1 lds
    buffer_load_dwordx4 v4, s[16:19], s62 offen offset:2048 sc1 lds
    buffer_load_dwordx4 v4, s[16:19], s62 offen offset:3072 sc1 lds
    s_add_u32 s62, s62, 8192
    s_add_u32 m0, s64, 16384
    s_nop 0
    buffer_load_dwordx4 v6, s[24:27], s63 offen offset:0 sc1 lds
    buffer_load_dwordx4 v6, s[24:27], s63 offen offset:1024 sc1 lds
    buffer_load_dwordx4 v6, s[24:27], s63 offen offset:2048 sc1 lds
    buffer_load_dwordx4 v6, s[24:27], s63 offen offset:3072 sc1 lds
    s_add_u32 m0, s64, 20480
    s_nop 0
    buffer_load_dwordx4 v7, s[24:27], s63 offen offset:0 sc1 lds
    buffer_load_dwordx4 v7, s[24:27], s63 offen offset:1024 sc1 lds
    buffer_load_dwordx4 v7, s[24:27], s63 offen offset:2048 sc1 lds
    buffer_load_dwordx4 v7, s[24:27], s63 offen offset:3072 sc1 lds
    s_add_u32 s63, s63, 8192
    s_waitcnt vmcnt(40)
    s_barrier
    s_branch B_LL
B_LE:
    s_barrier
    s_waitcnt vmcnt(8)
    s_barrier
    s_waitcnt vmcnt(0)
    s_barrier
    s_endpgm
B_LW:
    s_setprio 0
    s_cmp_ge_u32 s45, s47
    s_cselect_b32 s53, 1, 0
    s_lshr_b32 s42, s41, 3
    s_lshl_b32 s33, s40, 2
    s_add_u32 s33, s33, s42
    s_and_b32 s34, s41, 7
    v_lshlrev_b32 v3, 4, v0
    s_add_u32 s56, s14, 20971520
    s_addc_u32 s57, s15, 0
    s_cmp_eq_u32 s53, 1
    s_cbranch_scc1 B_LW1
    v_add_u32 v4, 4096, v3
    v_add_u32 v5, 8192, v3
    s_mov_b32 s62, 0
    s_mov_b32 s64, 0
    s_add_u32 s65, s33, 80
    s_lshl_b32 s65, s65, 8
    s_mul_i32 s50, s34, 276480
    s_add_u32 s50, s50, 8388608
    s_add_u32 s28, s14, s50
    s_addc_u32 s29, s15, 0
    s_mov_b32 s30, 276480
    s_mov_b32 s31, 0x20000
    s_mov_b32 s60, 0
    s_atomic_add s60, s[56:57], s65 glc
    s_waitcnt lgkmcnt(0)
    s_bfe_u32 s60, s60, 524304
    s_cmp_eq_u32 s60, 99
    s_cbranch_scc1 B_PWG
    v_mov_b32 v6, 159744
    s_mov_b32 s61, 4000000
L_36:
    ds_read_b32 v7, v6
    s_waitcnt lgkmcnt(0)
    v_readfirstlane_b32 s60, v7
    s_nop 1
    s_bfe_u32 s60, s60, 524288
    s_cmp_ge_u32 s60, 4
    s_cbranch_scc1 L_37
    s_sub_u32 s61, s61, 1
    s_cmp_lg_u32 s61, 0
    s_sleep 1
    s_cbranch_scc1 L_36
L_37:
    s_mov_b32 s61, 100000
L_38:
    s_mov_b32 s60, 0
    s_atomic_add s60, s[56:57], s65 glc
L_40:
    s_waitcnt lgkmcnt(0)
    s_bfe_u32 s60, s60, 524304
    s_cmp_eq_u32 s60, 8
    s_cbranch_scc1 L_39
    s_sub_u32 s61, s61, 1
    s_cmp_eq_u32 s61, 0
    s_cbranch_scc1 L_39
    s_sleep 2
    s_branch L_38
L_39:
B_PWG:
B_PW:
    s_add_u32 m0, s64, 0
    s_nop 0
    buffer_load_dwordx4 v3, s[28:31], s62 offen offset:0 sc1 lds
    buffer_load_dwordx4 v3, s[28:31], s62 offen offset:1024 sc1 lds
    buffer_load_dwordx4 v3, s[28:31], s62 offen offset:2048 sc1 lds
    buffer_load_dwordx4 v3, s[28:31], s62 offen offset:3072 sc1 lds
    s_add_u32 m0, s64, 4096
    s_nop 0
    buffer_load_dwordx4 v4, s[28:31], s62 offen offset:0 sc1 lds
    buffer_load_dwordx4 v4, s[28:31], s62 offen offset:1024 sc1 lds
    buffer_load_dwordx4 v4, s[28:31], s62 offen offset:2048 sc1 lds
    buffer_load_dwordx4 v4, s[28:31], s62 offen offset:3072 sc1 lds
    s_add_u32 m0, s64, 8192
    s_nop 0
    buffer_load_dwordx4 v5, s[28:31], s62 offen offset:0 sc1 lds
    buffer_load_dwordx4 v5, s[28:31], s62 offen offset:1024 sc1 lds
    s_add_u32 s62, s62, 10240
    s_add_u32 s64, s64, 10240
    s_cmp_lt_u32 s64, 71680
    s_waitcnt vmcnt(60)
    s_cbranch_scc1 B_PW
B_LW1:
    s_mul_i32 s50, s34, 276480
    s_add_u32 s50, s50, 8388608
    s_add_u32 s28, s14, s50
    s_addc_u32 s29, s15, 0
    s_mov_b32 s30, 276480
    s_mov_b32 s31, 0x20000
    v_add_u32 v4, 4096, v3
    v_add_u32 v5, 8192, v3
    s_mov_b32 s62, 71680
    s_mov_b32 s64, 0
    s_mov_b32 s48, 20
    s_waitcnt vmcnt(60)
    s_barrier
    s_waitcnt vmcnt(50)
    s_barrier
    s_waitcnt vmcnt(40)
    s_barrier
    s_setprio 3
B_LWL:
    s_add_u32 m0, s64, 0
    s_nop 0
    buffer_load_dwordx4 v3, s[28:31], s62 offen offset:0 sc1 lds
    buffer_load_dwordx4 v3, s[28:31], s62 offen offset:1024 sc1 lds
    buffer_load_dwordx4 v3, s[28:31], s62 offen offset:2048 sc1 lds
    buffer_load_dwordx4 v3, s[28:31], s62 offen offset:3072 sc1 lds
    s_add_u32 m0, s64, 4096
    s_nop 0
    buffer_load_dwordx4 v4, s[28:31], s62 offen offset:0 sc1 lds
    buffer_load_dwordx4 v4, s[28:31], s62 offen offset:1024 sc1 lds
    buffer_load_dwordx4 v4, s[28:31], s62 offen offset:2048 sc1 lds
    buffer_load_dwordx4 v4, s[28:31], s62 offen offset:3072 sc1 lds
    s_add_u32 m0, s64, 8192
    s_nop 0
    buffer_load_dwordx4 v5, s[28:31], s62 offen offset:0 sc1 lds
    buffer_load_dwordx4 v5, s[28:31], s62 offen offset:1024 sc1 lds
    s_add_u32 s62, s62, 10240
    s_add_u32 s64, s64, 10240
    s_cmp_eq_u32 s64, 81920
    s_cselect_b32 s64, 0, s64
    s_sub_u32 s48, s48, 1
    s_cmp_lg_u32 s48, 0
    s_waitcnt vmcnt(40)
    s_barrier
    s_cbranch_scc1 B_LWL
    s_waitcnt vmcnt(30)
    s_barrier
    s_waitcnt vmcnt(20)
    s_barrier
    s_waitcnt vmcnt(10)
    s_barrier
    s_waitcnt vmcnt(0)
    s_barrier
A_END:
CODE_END:
    s_endpgm
.section .rodata,"a"
.p2align 6
.amdhsa_kernel parallel_sum__spectral_gfnet__dense_activation_gelu__prompt_kernel
  .amdhsa_next_free_vgpr 256
  .amdhsa_next_free_sgpr 102
  .amdhsa_accum_offset 256
  .amdhsa_group_segment_fixed_size 0
  .amdhsa_kernarg_size 88
  .amdhsa_user_sgpr_count 2
  .amdhsa_user_sgpr_kernarg_segment_ptr 1
  .amdhsa_system_sgpr_workgroup_id_x 1
.end_amdhsa_kernel
```
